```python
import torch

def _softmax(x, axis=-1):
    return torch.softmax(x, dim=axis)
def _gelu(x):
    return torch.nn.functional.gelu(x, approximate="tanh")
def _silu(x):
    return torch.nn.functional.silu(x)
def _sigmoid(x):
    return torch.sigmoid(x)
def _layernorm(x, axis=-1, eps=1e-5):
    m = x.mean(dim=axis, keepdim=True)
    v = x.var(dim=axis, keepdim=True, unbiased=False)
    return (x - m) / torch.sqrt(v + eps)
def _scatter_add(tgt, idx, src, axis=0):
    return tgt.clone().index_add_(axis, idx, src)
def _segment_sum(src, seg, n):
    out = torch.zeros((n,) + src.shape[1:], dtype=src.dtype)
    return out.index_add_(0, seg, src)
def _pad(x, pw):
    flat = tuple(v for pair in reversed(pw) for v in pair)
    return torch.nn.functional.pad(x, flat)

kernel_name = 'recurrent_scan__ssm_conv_s4__dense_activation_squared_relu__prompt'

def setup_inputs():

    _w = (lambda a: (lambda t: t.to(torch.bfloat16) if t.is_floating_point() else t)(torch.as_tensor(a)))
    def _A_setup():
        B, L, D, N = 1, 2048, 512, 128
        A_re = -(lambda _x: torch.exp(torch.as_tensor(_x)))((lambda *s: torch.randn(*s, dtype=torch.bfloat16) * 3.2)(D, N))
        A_im = torch.pi * (lambda *s: torch.randn(*s, dtype=torch.bfloat16) * 0.05)(D, N)
        B_re = (lambda *s: torch.randn(*s, dtype=torch.bfloat16) * 0.2)(D, N)
        B_im = (lambda *s: torch.randn(*s, dtype=torch.bfloat16) * 0.1)(D, N)
        C_re = (lambda *s: torch.randn(*s, dtype=torch.bfloat16) * 0.2)(D, N)
        C_im = (lambda *s: torch.randn(*s, dtype=torch.bfloat16) * 0.2)(D, N)
        log_dt = (lambda *s: torch.randn(*s, dtype=torch.bfloat16) * 0.05)(D) * 0.5 - 4.0
        Dskip = (lambda *s: torch.randn(*s, dtype=torch.bfloat16) * 0.05)(D)
        return {
            "u": _w((lambda *s: torch.randn(*s, dtype=torch.bfloat16) * 0.05)(B, L, D)),
            "A_re": _w(A_re),
            "A_im": _w(A_im),
            "B_re": _w(B_re),
            "B_im": _w(B_im),
            "C_re": _w(C_re),
            "C_im": _w(C_im),
            "log_dt": _w(log_dt),
            "Dskip": _w(Dskip),
        }
    _A_in = _A_setup()

    def _B_setup():
        B, S, D, F = 1, 2048, 512, 1376
        return {
            "x": _w((lambda *s: torch.randn(*s, dtype=torch.bfloat16) * 0.05)(B, S, D)),
            "w1": _w((lambda *s: torch.randn(*s, dtype=torch.bfloat16) * 0.05)(D, F)),
            "b1": _w((lambda *s: torch.randn(*s, dtype=torch.bfloat16) * 0.4)(F)),
            "w2": _w((lambda *s: torch.randn(*s, dtype=torch.bfloat16) * 0.05)(F, D)),
            "b2": _w((lambda *s: torch.randn(*s, dtype=torch.bfloat16) * 1.6)(D)),
        }
    _B_in = _B_setup()

    return {
        "A_u": _A_in["u"],
        "A_A_re": _A_in["A_re"],
        "A_A_im": _A_in["A_im"],
        "A_B_re": _A_in["B_re"],
        "A_B_im": _A_in["B_im"],
        "A_C_re": _A_in["C_re"],
        "A_C_im": _A_in["C_im"],
        "A_log_dt": _A_in["log_dt"],
        "A_Dskip": _A_in["Dskip"],
        "B_x": _B_in["x"],
        "B_w1": _B_in["w1"],
        "B_b1": _B_in["b1"],
        "B_w2": _B_in["w2"],
        "B_b2": _B_in["b2"],
    }

def reference(A_u, A_A_re, A_A_im, A_B_re, A_B_im, A_C_re, A_C_im, A_log_dt, A_Dskip, B_x, B_w1, B_b1, B_w2, B_b2):
    def _A_ref(u, A_re, A_im, B_re, B_im, C_re, C_im, log_dt, Dskip):
        Bsz, L, D = u.shape
        dt = torch.exp(log_dt)[:, None]
        A = A_re + 1j * A_im
        Bc = B_re + 1j * B_im
        Cc = C_re + 1j * C_im
        logdA = dt * A
        dB = dt * Bc
        l = (lambda x, dt: x.to(dt))(torch.arange(L), A_re.dtype)
        P = torch.exp(logdA[:, :, None] * l[None, None, :])
        K = torch.einsum("dn,dnl,dn->dl", Cc, P, dB).real
        L2 = 2 * L
        Kp = _pad(K, ((0, 0), (0, L)))
        up = (lambda x, *d: x.permute(*d))(u, 0, 2, 1)
        up = _pad(up, ((0, 0), (0, 0), (0, L)))
        Kf = (lambda x, axes=(-2,-1): torch.fft.rfft2(x.float(), dim=axes))(Kp[:, None, :], axes=(-2, -1))
        Uf = (lambda x, axes=(-2,-1): torch.fft.rfft2(x.float(), dim=axes))(up[:, :, None, :], axes=(-2, -1))
        Yf = Uf * Kf[None, :, :, :]
        y = (lambda x, s, axes=(-2,-1): torch.fft.irfft2(x, s=s, dim=axes).to(torch.bfloat16))(Yf, (1, L2), axes=(-2, -1))[:, :, 0, :L]
        y = (lambda x, *d: x.permute(*d))(y, 0, 2, 1) + u * Dskip[None, None, :]
        return y

    def _B_ref(x, w1, b1, w2, b2):
        h = torch.einsum("bsd,df->bsf", x, w1) + b1
        zero = torch.zeros_like(h)
        r = torch.where(h > zero, h, zero)
        h = r * r
        out = torch.einsum("bsf,fd->bsd", h, w2) + b2
        return out

    x = A_u
    xn = _layernorm(x, axis=-1)
    s = _A_ref(xn, A_A_re, A_A_im, A_B_re, A_B_im, A_C_re, A_C_im, A_log_dt, A_Dskip)
    g = _silu(_B_ref(xn, B_w1, B_b1, B_w2, B_b2))
    return x + s * g
```

```asm
; @launch grid=(256,1,1) block=(256,1,1) lds=163840
.amdgcn_target "amdgcn-amd-amdhsa--gfx950"
.text
.globl recurrent_scan__ssm_conv_s4__dense_activation_squared_relu__prompt_kernel
.p2align 8
.type recurrent_scan__ssm_conv_s4__dense_activation_squared_relu__prompt_kernel,@function
recurrent_scan__ssm_conv_s4__dense_activation_squared_relu__prompt_kernel:
  s_cmp_ge_u32 s2, 256
  s_cbranch_scc1 L_end
  s_load_dwordx16 s[16:31], s[0:1], 0
  s_load_dwordx16 s[32:47], s[0:1], 64
  s_load_dwordx2 s[48:49], s[0:1], 128
  s_getpc_b64 s[12:13]
  s_lshr_b32 s5, s2, 3
  v_and_b32 v160, 7, v0
  v_lshl_add_u32 v160, s5, 3, v160
  v_lshlrev_b32 v160, 7, v160
  v_lshrrev_b32 v2, 6, v0
  global_load_dword v255, v160, s[12:13]
  v_readfirstlane_b32 s3, v2
  v_and_b32 v1, 63, v0
  s_and_b32 s4, s2, 7
  s_lshl_b32 s12, s4, 5
  s_add_u32 s8, s12, s5
  v_lshlrev_b32 v2, 4, v1
  s_lshl2_add_u32 s85, s8, s3
  s_lshl_b32 s99, s85, 11
  s_lshl_b32 s13, s85, 7
  v_lshl_add_u32 v162, v1, 1, s13
  s_mov_b32 s54, 2097152
  s_mov_b32 s55, 0x00020000
  s_and_b32 s50, s3, 1
  s_lshr_b32 s51, s3, 1
  v_mov_b32 v164, 13107200
  s_lshl_b32 s85, s85, 5
  s_add_u32 s85, s85, 12582912
  s_and_b32 s12, s5, 1
  s_lshl1_add_u32 s6, s4, s12
  s_lshl_b32 s78, s12, 2
  s_lshr_b32 s7, s5, 1
  s_and_b32 s13, s5, 3
  s_lshr_b32 s10, s5, 2
  s_lshl2_add_u32 s9, s4, s13
  s_lshl2_add_u32 s92, s2, s3
  v_add_u32 v166, 0, v1
  v_mul_u32_u24 v167, 5462, v166
  v_lshrrev_b32 v167, 16, v167
  v_mul_u32_u24 v168, 2560, v167
  v_lshl_add_u32 v7, v1, 4, v168
  v_add_u32 v166, 64, v1
  v_mul_u32_u24 v167, 5462, v166
  v_lshrrev_b32 v167, 16, v167
  v_mul_u32_u24 v168, 2560, v167
  v_lshl_add_u32 v8, v1, 4, v168
  v_add_u32 v166, 128, v1
  v_mul_u32_u24 v167, 5462, v166
  v_lshrrev_b32 v167, 16, v167
  v_mul_u32_u24 v168, 2560, v167
  v_lshl_add_u32 v9, v1, 4, v168
  s_mul_i32 s12, s3, 352256
  s_mul_i32 s15, s7, 192
  s_add_u32 s93, s12, s15
  s_mul_i32 s94, s3, 24576
  s_add_u32 s94, s94, 56320
  s_mov_b32 s62, 1409024
  s_mov_b32 s63, 0x00020000
  s_waitcnt lgkmcnt(0)
  s_mov_b32 s52, s16
  s_mov_b32 s53, s17
  buffer_load_dwordx4 v[208:211], v2, s[52:55], s99 offen
  buffer_load_dwordx4 v[212:215], v2, s[52:55], s99 offen offset:1024
  s_mov_b32 s60, s36
  s_mov_b32 s61, s37
  s_add_u32 s56, s48, 0
  s_addc_u32 s57, s49, 0
  s_mov_b32 s58, 268435456
  s_mov_b32 s59, 0x00020000
  buffer_load_dword v5, v164, s[56:59], 0 offen sc1
  global_load_ushort v216, v162, s[18:19]
  global_load_ushort v217, v162, s[20:21]
  global_load_ushort v218, v162, s[22:23]
  global_load_ushort v219, v162, s[24:25]
  global_load_ushort v220, v162, s[26:27]
  global_load_ushort v221, v162, s[28:29]
  s_add_u32 s34, s78, 7
  s_and_b32 s34, s34, 7
  s_mul_i32 s34, s34, 3072
  s_add_u32 s24, s34, s94
  s_lshl_b32 s46, s8, 2
  s_load_dword s47, s[30:31], s46
  s_load_dword s46, s[32:33], s46
  s_mul_i32 s76, s78, 44032
  s_mul_i32 s77, s78, 3072
  s_add_u32 s76, s76, s93
  s_add_u32 m0, s77, s94
  s_add_u32 s78, s78, 1
  buffer_load_dwordx4 v7, s[60:63], s76 offen offset:0 lds
  buffer_load_dwordx4 v8, s[60:63], s76 offen offset:1024 lds
  buffer_load_dwordx4 v9, s[60:63], s76 offen offset:2048 lds
  s_and_b32 s78, s78, 7
  v_lshlrev_b32 v166, 1, v1
  v_mov_b32 v167, 0x100000
  v_cmp_gt_u32 vcc, 32, v1
  s_lshl1_add_u32 s12, s10, s50
  s_lshl_b32 s95, s12, 6
  v_cndmask_b32 v166, v167, v166, vcc
  s_mov_b32 s72, s38
  s_mov_b32 s73, s39
  s_mov_b32 s74, 2752
  s_mov_b32 s75, 0x00020000
  s_mov_b32 s16, s42
  s_mov_b32 s17, s43
  s_mov_b32 s18, 1024
  s_mov_b32 s19, 0x00020000
  v_mov_b32 v230, v166
  s_mov_b32 s27, s15
  v_lshrrev_b32 v165, 3, v1
  v_lshlrev_b32 v165, 10, v165
  v_and_b32 v166, 7, v1
  v_bfe_u32 v174, v1, 4, 1
  v_lshlrev_b32 v167, 2, v174
  v_xor_b32 v166, v166, v167
  v_lshl_add_u32 v231, v166, 4, v165
  s_mov_b32 s64, s40
  s_mov_b32 s65, s41
  s_mov_b32 s66, 1409024
  s_mov_b32 s67, 0x00020000
  s_lshr_b32 s34, s92, 3
  s_and_b32 s35, s92, 7
  s_lshl_b32 s12, s34, 14
  s_lshl_b32 s13, s35, 7
  s_add_u32 s28, s12, s13
  s_add_u32 s29, s28, 7168
  s_mul_i32 s12, s3, 2080
  s_add_u32 s12, s12, 154624
  v_add_u32 v168, s12, v2
  v_and_b32 v171, 7, v0
  v_lshrrev_b32 v172, 3, v0
  v_mul_u32_u24 v169, 1040, v171
  v_lshl_add_u32 v169, v172, 4, v169
  v_add_u32 v169, 154624, v169
  v_lshlrev_b32 v172, 9, v172
  v_lshl_add_u32 v170, v171, 4, v172
  s_lshr_b32 s12, s8, 2
  s_lshl_b32 s12, s12, 8
  s_and_b32 s13, s8, 3
  s_add_u32 s12, s12, s13
  s_lshl_b32 s96, s12, 7
  s_add_u32 s26, s96, 16384
  s_mul_i32 s35, s35, 88
  s_add_u32 s12, s35, s34
  s_lshl_b32 s12, s12, 11
  s_add_u32 s12, s12, 14680064
  s_cmp_lt_u32 s92, 704
  s_cselect_b32 s97, s12, 1879048192
  s_and_b32 s12, s92, 7
  s_lshl_b32 s12, s12, 7
  s_add_u32 s12, s12, s34
  s_lshl_b32 s98, s12, 4
  s_add_u32 s98, s98, 12976128
  s_lshl_b32 s12, s3, 8
  s_add_u32 s12, s12, s8
  s_lshl_b32 s12, s12, 2
  s_add_u32 s39, s12, 13238272
  s_mul_i32 s20, s51, 27984
  s_lshl_b32 s14, s50, 8
  v_lshrrev_b32 v160, 5, v1
  v_bfe_u32 v161, v1, 2, 2
  v_lshl_add_u32 v173, v160, 3, v161
  v_mul_u32_u24 v173, 192, v173
  v_and_b32 v175, 3, v1
  v_lshlrev_b32 v175, 3, v175
  v_lshl_add_u32 v175, v174, 5, v175
  v_add_u32 v173, v173, v175
  v_add_u32 v3, 56320, v173
  v_add_u32 v4, 105472, v173
  v_lshl_add_u32 v173, v160, 2, v161
  v_lshl_add_u32 v250, v173, 6, v175
  v_lshlrev_b32 v173, 7, v173
  v_lshlrev_b32 v174, 1, v174
  v_bfe_u32 v175, v1, 1, 1
  v_add_u32 v174, v174, v175
  v_bfe_u32 v175, v1, 3, 1
  v_lshlrev_b32 v175, 2, v175
  v_xor_b32 v174, v174, v175
  v_lshl_add_u32 v173, v174, 4, v173
  v_and_b32 v174, 1, v1
  v_lshl_add_u32 v173, v174, 3, v173
  v_add_u32 v252, s24, v173
  v_xor_b32 v253, 64, v252
  s_lshl2_add_u32 s12, s6, s3
  s_lshl_b32 s80, s12, 15
  s_lshl_b32 s13, s12, 9
  s_add_u32 s13, s13, 12582912
  v_and_b32 v12, 15, v1
  v_lshl_add_u32 v18, v12, 5, s13
  v_mov_b32 v6, 0
  v_mov_b32 v28, 0x3f80
  v_mov_b32 v29, 0
  v_mov_b32 v30, 0
  v_mov_b32 v31, 0
  v_lshrrev_b32 v13, 4, v1
  v_or_b32 v17, v12, v13
  v_or_b32 v17, s50, v17
  s_add_u32 s20, s20, s14
  v_accvgpr_write_b32 a241, 0
  v_accvgpr_write_b32 a242, 0
  v_accvgpr_write_b32 a243, 0
  v_accvgpr_write_b32 a245, 0
  v_accvgpr_write_b32 a246, 0
  v_accvgpr_write_b32 a247, 0
  v_accvgpr_write_b32 a249, 0
  v_accvgpr_write_b32 a250, 0
  v_accvgpr_write_b32 a251, 0
  v_accvgpr_write_b32 a253, 0
  v_accvgpr_write_b32 a254, 0
  v_accvgpr_write_b32 a255, 0
  s_mov_b32 s68, s44
  s_mov_b32 s69, s45
  s_mov_b32 s70, 2097152
  s_mov_b32 s71, 0x00020000
  s_mul_i32 s76, s78, 44032
  s_mul_i32 s77, s78, 3072
  s_add_u32 s76, s76, s93
  s_add_u32 m0, s77, s94
  s_add_u32 s78, s78, 1
  buffer_load_dwordx4 v7, s[60:63], s76 offen offset:0 lds
  buffer_load_dwordx4 v8, s[60:63], s76 offen offset:1024 lds
  buffer_load_dwordx4 v9, s[60:63], s76 offen offset:2048 lds
  s_and_b32 s78, s78, 7
  s_mul_i32 s76, s78, 44032
  s_mul_i32 s77, s78, 3072
  s_add_u32 s76, s76, s93
  s_add_u32 m0, s77, s94
  s_add_u32 s78, s78, 1
  buffer_load_dwordx4 v7, s[60:63], s76 offen offset:0 lds
  buffer_load_dwordx4 v8, s[60:63], s76 offen offset:1024 lds
  buffer_load_dwordx4 v9, s[60:63], s76 offen offset:2048 lds
  s_and_b32 s78, s78, 7
  s_mov_b32 s12, 0x3f803f80
  s_waitcnt vmcnt(17)
  v_dot2_f32_bf16 v176, v208, s12, 0
  v_dot2_f32_bf16 v178, v208, v208, 0
  s_waitcnt vmcnt(16)
  v_dot2_f32_bf16 v177, v212, s12, 0
  v_dot2_f32_bf16 v179, v212, v212, 0
  v_dot2_f32_bf16 v176, v209, s12, v176
  v_dot2_f32_bf16 v178, v209, v209, v178
  v_dot2_f32_bf16 v177, v213, s12, v177
  v_dot2_f32_bf16 v179, v213, v213, v179
  v_dot2_f32_bf16 v176, v210, s12, v176
  v_dot2_f32_bf16 v178, v210, v210, v178
  v_dot2_f32_bf16 v177, v214, s12, v177
  v_dot2_f32_bf16 v179, v214, v214, v179
  v_dot2_f32_bf16 v176, v211, s12, v176
  v_dot2_f32_bf16 v178, v211, v211, v178
  v_dot2_f32_bf16 v177, v215, s12, v177
  v_dot2_f32_bf16 v179, v215, v215, v179
  v_add_f32_dpp v176, v176, v176 row_shr:1 row_mask:0xf bank_mask:0xf bound_ctrl:0
  s_nop 0
  v_add_f32_dpp v177, v177, v177 row_shr:1 row_mask:0xf bank_mask:0xf bound_ctrl:0
  v_add_f32_dpp v178, v178, v178 row_shr:1 row_mask:0xf bank_mask:0xf bound_ctrl:0
  v_add_f32_dpp v179, v179, v179 row_shr:1 row_mask:0xf bank_mask:0xf bound_ctrl:0
  v_add_f32_dpp v176, v176, v176 row_shr:2 row_mask:0xf bank_mask:0xf bound_ctrl:0
  v_add_f32_dpp v177, v177, v177 row_shr:2 row_mask:0xf bank_mask:0xf bound_ctrl:0
  v_add_f32_dpp v178, v178, v178 row_shr:2 row_mask:0xf bank_mask:0xf bound_ctrl:0
  v_add_f32_dpp v179, v179, v179 row_shr:2 row_mask:0xf bank_mask:0xf bound_ctrl:0
  v_add_f32_dpp v176, v176, v176 row_shr:4 row_mask:0xf bank_mask:0xf bound_ctrl:0
  v_add_f32_dpp v177, v177, v177 row_shr:4 row_mask:0xf bank_mask:0xf bound_ctrl:0
  v_add_f32_dpp v178, v178, v178 row_shr:4 row_mask:0xf bank_mask:0xf bound_ctrl:0
  v_add_f32_dpp v179, v179, v179 row_shr:4 row_mask:0xf bank_mask:0xf bound_ctrl:0
  v_add_f32_dpp v176, v176, v176 row_shr:8 row_mask:0xf bank_mask:0xf bound_ctrl:0
  v_add_f32_dpp v177, v177, v177 row_shr:8 row_mask:0xf bank_mask:0xf bound_ctrl:0
  v_add_f32_dpp v178, v178, v178 row_shr:8 row_mask:0xf bank_mask:0xf bound_ctrl:0
  v_add_f32_dpp v179, v179, v179 row_shr:8 row_mask:0xf bank_mask:0xf bound_ctrl:0
  v_add_f32_dpp v176, v176, v176 row_bcast:15 row_mask:0xa bank_mask:0xf
  v_add_f32_dpp v177, v177, v177 row_bcast:15 row_mask:0xa bank_mask:0xf
  v_add_f32_dpp v178, v178, v178 row_bcast:15 row_mask:0xa bank_mask:0xf
  v_add_f32_dpp v179, v179, v179 row_bcast:15 row_mask:0xa bank_mask:0xf
  v_add_f32_dpp v176, v176, v176 row_bcast:31 row_mask:0xc bank_mask:0xf
  v_add_f32_dpp v177, v177, v177 row_bcast:31 row_mask:0xc bank_mask:0xf
  v_add_f32_dpp v178, v178, v178 row_bcast:31 row_mask:0xc bank_mask:0xf
  v_add_f32_dpp v179, v179, v179 row_bcast:31 row_mask:0xc bank_mask:0xf
  v_readlane_b32 s12, v176, 63
  v_readlane_b32 s13, v177, 63
  v_readlane_b32 s14, v178, 63
  v_readlane_b32 s15, v179, 63
  v_mov_b32 v180, 0x3b000000
  v_lshlrev_b32 v184, 16, v208
  v_mul_f32 v176, s12, v180
  v_and_b32 v185, 0xffff0000, v208
  v_mul_f32 v177, s13, v180
  v_mul_f32 v178, s14, v180
  v_lshlrev_b32 v186, 16, v209
  v_mul_f32 v179, s15, v180
  v_and_b32 v187, 0xffff0000, v209
  v_pk_fma_f32 v[178:179], v[176:177], v[176:177], v[178:179] neg_lo:[1,0,0] neg_hi:[1,0,0]
  v_max_f32 v178, 0, v178
  v_lshlrev_b32 v188, 16, v210
  v_max_f32 v179, 0, v179
  v_cvt_pk_bf16_f32 v181, v178, v179
  v_and_b32 v189, 0xffff0000, v210
  v_lshlrev_b32 v178, 16, v181
  v_lshlrev_b32 v190, 16, v211
  v_and_b32 v179, 0xffff0000, v181
  v_add_f32 v178, 0x3727c5ac, v178
  v_and_b32 v191, 0xffff0000, v211
  v_add_f32 v179, 0x3727c5ac, v179
  v_cvt_pk_bf16_f32 v181, v178, v179
  v_lshlrev_b32 v192, 16, v212
  v_lshlrev_b32 v178, 16, v181
  v_and_b32 v193, 0xffff0000, v212
  v_and_b32 v179, 0xffff0000, v181
  v_sqrt_f32 v178, v178
  v_lshlrev_b32 v194, 16, v213
  v_sqrt_f32 v179, v179
  v_and_b32 v195, 0xffff0000, v213
  v_cvt_pk_bf16_f32 v180, v176, v177
  v_lshlrev_b32 v176, 16, v180
  v_lshlrev_b32 v196, 16, v214
  v_and_b32 v177, 0xffff0000, v180
  v_cvt_pk_bf16_f32 v181, v178, v179
  v_and_b32 v197, 0xffff0000, v214
  v_lshlrev_b32 v178, 16, v181
  v_lshlrev_b32 v198, 16, v215
  v_and_b32 v179, 0xffff0000, v181
  v_rcp_f32 v178, v178
  v_and_b32 v199, 0xffff0000, v215
  v_rcp_f32 v179, v179
  s_waitcnt vmcnt(15)
  v_readfirstlane_b32 s11, v5
  v_pk_mul_f32 v[176:177], v[176:177], v[178:179] neg_lo:[1,0] neg_hi:[1,0]
  v_pk_fma_f32 v[184:185], v[184:185], v[178:179], v[176:177] op_sel:[0,0,0] op_sel_hi:[1,0,0]
  v_pk_fma_f32 v[186:187], v[186:187], v[178:179], v[176:177] op_sel:[0,0,0] op_sel_hi:[1,0,0]
  v_pk_fma_f32 v[188:189], v[188:189], v[178:179], v[176:177] op_sel:[0,0,0] op_sel_hi:[1,0,0]
  v_pk_fma_f32 v[190:191], v[190:191], v[178:179], v[176:177] op_sel:[0,0,0] op_sel_hi:[1,0,0]
  v_cvt_pk_bf16_f32 v208, v184, v185
  v_cvt_pk_bf16_f32 v209, v186, v187
  v_cvt_pk_bf16_f32 v210, v188, v189
  v_cvt_pk_bf16_f32 v211, v190, v191
  ds_write_b128 v168, v[208:211] offset:0
  v_pk_fma_f32 v[192:193], v[192:193], v[178:179], v[176:177] op_sel:[0,1,1] op_sel_hi:[1,1,1]
  v_pk_fma_f32 v[194:195], v[194:195], v[178:179], v[176:177] op_sel:[0,1,1] op_sel_hi:[1,1,1]
  v_pk_fma_f32 v[196:197], v[196:197], v[178:179], v[176:177] op_sel:[0,1,1] op_sel_hi:[1,1,1]
  v_pk_fma_f32 v[198:199], v[198:199], v[178:179], v[176:177] op_sel:[0,1,1] op_sel_hi:[1,1,1]
  v_cvt_pk_bf16_f32 v212, v192, v193
  v_cvt_pk_bf16_f32 v213, v194, v195
  v_cvt_pk_bf16_f32 v214, v196, v197
  v_cvt_pk_bf16_f32 v215, v198, v199
  ds_write_b128 v168, v[212:215] offset:1040
  s_mul_i32 s11, s11, 0x9E3779B1
  s_add_u32 s11, s11, 0x7F4A7C15
  s_waitcnt lgkmcnt(0)
  s_barrier
  ds_read_b128 v[176:179], v169
  ds_read_b128 v[180:183], v169 offset:512
  v_mov_b32 v5, s11
  s_waitcnt lgkmcnt(1)
  buffer_store_dwordx4 v[176:179], v170, s[56:59], s96 offen sc1
  s_waitcnt lgkmcnt(0)
  buffer_store_dwordx4 v[180:183], v170, s[56:59], s26 offen sc1
  s_mov_b32 m0, s20
  .p2alignl 3, 0xbf800000
  s_lshl_b32 s12, s51, 4
  s_lshr_b32 s47, s47, s12
  s_lshl_b32 s47, s47, 16
  s_lshr_b32 s46, s46, s12
  s_lshl_b32 s46, s46, 16
  v_mov_b32 v222, s47
  v_mov_b32 v223, s46
  s_waitcnt vmcnt(16)
  v_lshlrev_b32 v216, 16, v216
  s_waitcnt vmcnt(15)
  v_lshlrev_b32 v217, 16, v217
  s_waitcnt vmcnt(14)
  v_lshlrev_b32 v218, 16, v218
  s_waitcnt vmcnt(13)
  v_lshlrev_b32 v219, 16, v219
  s_waitcnt vmcnt(12)
  v_lshlrev_b32 v220, 16, v220
  s_waitcnt vmcnt(11)
  v_lshlrev_b32 v221, 16, v221
  v_mul_f32 v222, 0x3fb8aa3b, v222
  v_exp_f32 v222, v222
  v_cmp_eq_u32 vcc, 0, v17
  v_cvt_pk_bf16_f32 v222, v222, v222
  v_lshlrev_b32 v222, 16, v222
  v_cndmask_b32 v17, 0, v223, vcc
  v_mul_f32 v216, v222, v216
  v_mul_f32 v217, v222, v217
  v_mul_f32 v218, v222, v218
  v_mul_f32 v219, v222, v219
  v_mul_f32 v216, 0x3fb8aa3b, v216
  v_mul_f32 v217, 0x3e22f983, v217
  v_pk_mul_f32 v[160:161], v[220:221], v[218:219] op_sel:[0,0] op_sel_hi:[0,1]
  v_pk_fma_f32 v[160:161], v[220:221], v[218:219], v[160:161] op_sel:[1,1,0] op_sel_hi:[1,0,1] neg_lo:[1,0,0]
  v_mul_f32 v224, 0x3f800000, v217
  v_mul_f32 v225, 0x3f800000, v216
  v_mul_f32 v226, 0x41000000, v217
  v_mul_f32 v227, 0x41000000, v216
  v_mul_f32 v228, 0x43800000, v217
  v_mul_f32 v229, 0x43800000, v216
  v_fract_f32 v224, v224
  v_exp_f32 v225, v225
  v_fract_f32 v226, v226
  v_exp_f32 v227, v227
  v_fract_f32 v228, v228
  v_exp_f32 v229, v229
  v_cos_f32 v162, v224
  v_sin_f32 v163, v224
  v_cos_f32 v164, v226
  v_sin_f32 v165, v226
  v_cos_f32 v166, v228
  v_sin_f32 v167, v228
  v_mul_f32 v162, v225, v162
  v_mul_f32 v163, v225, v163
  v_mul_f32 v164, v227, v164
  v_mul_f32 v165, v227, v165
  v_mul_f32 v166, v229, v166
  v_mul_f32 v167, v229, v167
  ds_write_addtid_b32 v28
  v_pk_mul_f32 v[178:179], v[164:165], v[164:165] op_sel:[0,0] op_sel_hi:[0,1]
  v_pk_fma_f32 v[178:179], v[164:165], v[164:165], v[178:179] op_sel:[1,1,0] op_sel_hi:[1,0,1] neg_lo:[1,0,0]
  v_cvt_pk_bf16_f32 v224, v164, v165
  ds_write_addtid_b32 v224 offset:528
  v_pk_mul_f32 v[168:169], v[166:167], v[166:167] op_sel:[0,0] op_sel_hi:[0,1]
  v_pk_fma_f32 v[168:169], v[166:167], v[166:167], v[168:169] op_sel:[1,1,0] op_sel_hi:[1,0,1] neg_lo:[1,0,0]
  v_cvt_pk_bf16_f32 v225, v160, -v161
  ds_write_addtid_b32 v225 offset:16896
  v_pk_mul_f32 v[180:181], v[178:179], v[164:165] op_sel:[0,0] op_sel_hi:[0,1]
  v_pk_fma_f32 v[180:181], v[178:179], v[164:165], v[180:181] op_sel:[1,1,0] op_sel_hi:[1,0,1] neg_lo:[1,0,0]
  v_pk_mul_f32 v[172:173], v[178:179], v[178:179] op_sel:[0,0] op_sel_hi:[0,1]
  v_pk_fma_f32 v[172:173], v[178:179], v[178:179], v[172:173] op_sel:[1,1,0] op_sel_hi:[1,0,1] neg_lo:[1,0,0]
  v_cvt_pk_bf16_f32 v226, v178, v179
  ds_write_addtid_b32 v226 offset:1056
  v_pk_mul_f32 v[170:171], v[168:169], v[168:169] op_sel:[0,0] op_sel_hi:[0,1]
  v_pk_fma_f32 v[170:171], v[168:169], v[168:169], v[170:171] op_sel:[1,1,0] op_sel_hi:[1,0,1] neg_lo:[1,0,0]
  v_pk_mul_f32 v[184:185], v[164:165], v[172:173] op_sel:[0,0] op_sel_hi:[0,1]
  v_pk_fma_f32 v[184:185], v[164:165], v[172:173], v[184:185] op_sel:[1,1,0] op_sel_hi:[1,0,1] neg_lo:[1,0,0]
  v_cvt_pk_bf16_f32 v227, v180, v181
  ds_write_addtid_b32 v227 offset:1584
  v_pk_mul_f32 v[186:187], v[178:179], v[172:173] op_sel:[0,0] op_sel_hi:[0,1]
  v_pk_fma_f32 v[186:187], v[178:179], v[172:173], v[186:187] op_sel:[1,1,0] op_sel_hi:[1,0,1] neg_lo:[1,0,0]
  v_cvt_pk_bf16_f32 v224, v172, v173
  ds_write_addtid_b32 v224 offset:2112
  v_pk_mul_f32 v[188:189], v[180:181], v[172:173] op_sel:[0,0] op_sel_hi:[0,1]
  v_pk_fma_f32 v[188:189], v[180:181], v[172:173], v[188:189] op_sel:[1,1,0] op_sel_hi:[1,0,1] neg_lo:[1,0,0]
  v_cvt_pk_bf16_f32 v225, v184, v185
  ds_write_addtid_b32 v225 offset:2640
  v_cvt_pk_bf16_f32 v226, v186, v187
  ds_write_addtid_b32 v226 offset:3168
  v_cvt_pk_bf16_f32 v227, v188, v189
  ds_write_addtid_b32 v227 offset:3696
  v_pk_mul_f32 v[174:175], v[172:173], v[172:173] op_sel:[0,0] op_sel_hi:[0,1]
  v_pk_fma_f32 v[174:175], v[172:173], v[172:173], v[174:175] op_sel:[1,1,0] op_sel_hi:[1,0,1] neg_lo:[1,0,0]
  v_cvt_pk_bf16_f32 v224, v174, v175
  ds_write_addtid_b32 v224 offset:4224
  v_pk_mul_f32 v[190:191], v[160:161], v[162:163] op_sel:[0,0] op_sel_hi:[0,1]
  v_pk_fma_f32 v[190:191], v[160:161], v[162:163], v[190:191] op_sel:[1,1,0] op_sel_hi:[1,0,1] neg_lo:[1,0,0]
  v_cvt_pk_bf16_f32 v225, v190, -v191
  ds_write_addtid_b32 v225 offset:17424
  v_pk_mul_f32 v[176:177], v[184:185], v[172:173] op_sel:[0,0] op_sel_hi:[0,1]
  v_pk_fma_f32 v[176:177], v[184:185], v[172:173], v[176:177] op_sel:[1,1,0] op_sel_hi:[1,0,1] neg_lo:[1,0,0]
  v_cvt_pk_bf16_f32 v226, v176, v177
  ds_write_addtid_b32 v226 offset:4752
  v_pk_mul_f32 v[192:193], v[190:191], v[162:163] op_sel:[0,0] op_sel_hi:[0,1]
  s_mul_i32 s76, s78, 44032
  s_mul_i32 s77, s78, 3072
  s_add_u32 s76, s76, s93
  s_add_u32 m0, s77, s94
  s_add_u32 s78, s78, 1
  buffer_load_dwordx4 v7, s[60:63], s76 offen offset:0 lds
  buffer_load_dwordx4 v8, s[60:63], s76 offen offset:1024 lds
  buffer_load_dwordx4 v9, s[60:63], s76 offen offset:2048 lds
  s_and_b32 s78, s78, 7
  s_mov_b32 m0, s20
  v_pk_fma_f32 v[192:193], v[190:191], v[162:163], v[192:193] op_sel:[1,1,0] op_sel_hi:[1,0,1] neg_lo:[1,0,0]
  v_cvt_pk_bf16_f32 v227, v192, -v193
  ds_write_addtid_b32 v227 offset:17952
  v_pk_mul_f32 v[178:179], v[186:187], v[172:173] op_sel:[0,0] op_sel_hi:[0,1]
  v_pk_fma_f32 v[178:179], v[186:187], v[172:173], v[178:179] op_sel:[1,1,0] op_sel_hi:[1,0,1] neg_lo:[1,0,0]
  v_cvt_pk_bf16_f32 v224, v178, v179
  ds_write_addtid_b32 v224 offset:5280
  v_pk_mul_f32 v[194:195], v[192:193], v[162:163] op_sel:[0,0] op_sel_hi:[0,1]
  v_pk_fma_f32 v[194:195], v[192:193], v[162:163], v[194:195] op_sel:[1,1,0] op_sel_hi:[1,0,1] neg_lo:[1,0,0]
  v_cvt_pk_bf16_f32 v225, v194, -v195
  ds_write_addtid_b32 v225 offset:18480
  v_pk_mul_f32 v[180:181], v[188:189], v[172:173] op_sel:[0,0] op_sel_hi:[0,1]
  v_pk_fma_f32 v[180:181], v[188:189], v[172:173], v[180:181] op_sel:[1,1,0] op_sel_hi:[1,0,1] neg_lo:[1,0,0]
  s_mov_b32 m0, s24
  s_nop 0
  buffer_load_dwordx4 v231, s[64:67], s28 offen lds
  buffer_load_dwordx4 v231, s[64:67], s29 offen offset:1024 lds
  s_mov_b32 m0, s20
  v_cvt_pk_bf16_f32 v226, v180, v181
  ds_write_addtid_b32 v226 offset:5808
  v_pk_mul_f32 v[196:197], v[194:195], v[162:163] op_sel:[0,0] op_sel_hi:[0,1]
  v_pk_fma_f32 v[196:197], v[194:195], v[162:163], v[196:197] op_sel:[1,1,0] op_sel_hi:[1,0,1] neg_lo:[1,0,0]
  buffer_load_ushort a240, v230, s[72:75], s27 offen offset:0
  v_cvt_pk_bf16_f32 v227, v196, -v197
  ds_write_addtid_b32 v227 offset:19008
  v_pk_mul_f32 v[182:183], v[174:175], v[172:173] op_sel:[0,0] op_sel_hi:[0,1]
  v_pk_fma_f32 v[182:183], v[174:175], v[172:173], v[182:183] op_sel:[1,1,0] op_sel_hi:[1,0,1] neg_lo:[1,0,0]
  buffer_load_ushort a244, v230, s[72:75], s27 offen offset:64
  v_cvt_pk_bf16_f32 v224, v182, v183
  ds_write_addtid_b32 v224 offset:6336
  v_pk_mul_f32 v[198:199], v[196:197], v[162:163] op_sel:[0,0] op_sel_hi:[0,1]
  v_pk_fma_f32 v[198:199], v[196:197], v[162:163], v[198:199] op_sel:[1,1,0] op_sel_hi:[1,0,1] neg_lo:[1,0,0]
  buffer_load_ushort a248, v230, s[72:75], s27 offen offset:128
  v_cvt_pk_bf16_f32 v225, v198, -v199
  ds_write_addtid_b32 v225 offset:19536
  v_pk_mul_f32 v[184:185], v[176:177], v[172:173] op_sel:[0,0] op_sel_hi:[0,1]
  v_pk_fma_f32 v[184:185], v[176:177], v[172:173], v[184:185] op_sel:[1,1,0] op_sel_hi:[1,0,1] neg_lo:[1,0,0]
  buffer_load_ushort a252, v230, s[16:19], s95 offen
  v_cvt_pk_bf16_f32 v226, v184, v185
  ds_write_addtid_b32 v226 offset:6864
  v_pk_mul_f32 v[208:209], v[198:199], v[162:163] op_sel:[0,0] op_sel_hi:[0,1]
  v_pk_fma_f32 v[208:209], v[198:199], v[162:163], v[208:209] op_sel:[1,1,0] op_sel_hi:[1,0,1] neg_lo:[1,0,0]
  v_cvt_pk_bf16_f32 v227, v208, -v209
  ds_write_addtid_b32 v227 offset:20064
  v_pk_mul_f32 v[186:187], v[178:179], v[172:173] op_sel:[0,0] op_sel_hi:[0,1]
  v_pk_fma_f32 v[186:187], v[178:179], v[172:173], v[186:187] op_sel:[1,1,0] op_sel_hi:[1,0,1] neg_lo:[1,0,0]
  v_cvt_pk_bf16_f32 v224, v186, v187
  s_waitcnt vmcnt(9)
  s_mov_b64 exec, 1
  buffer_store_dword v5, v6, s[56:59], s85 offen sc1
  buffer_store_dword v5, v6, s[56:59], s39 offen sc1
  s_mov_b64 exec, -1
  ds_write_addtid_b32 v224 offset:7392
  v_pk_mul_f32 v[210:211], v[208:209], v[162:163] op_sel:[0,0] op_sel_hi:[0,1]
  v_pk_fma_f32 v[210:211], v[208:209], v[162:163], v[210:211] op_sel:[1,1,0] op_sel_hi:[1,0,1] neg_lo:[1,0,0]
  v_cvt_pk_bf16_f32 v225, v210, -v211
  ds_write_addtid_b32 v225 offset:20592
  v_pk_mul_f32 v[188:189], v[180:181], v[172:173] op_sel:[0,0] op_sel_hi:[0,1]
  v_pk_fma_f32 v[188:189], v[180:181], v[172:173], v[188:189] op_sel:[1,1,0] op_sel_hi:[1,0,1] neg_lo:[1,0,0]
  v_cvt_pk_bf16_f32 v226, v188, v189
  ds_write_addtid_b32 v226 offset:7920
  v_pk_mul_f32 v[212:213], v[160:161], v[166:167] op_sel:[0,0] op_sel_hi:[0,1]
  v_pk_fma_f32 v[212:213], v[160:161], v[166:167], v[212:213] op_sel:[1,1,0] op_sel_hi:[1,0,1] neg_lo:[1,0,0]
  v_cvt_pk_bf16_f32 v227, v212, -v213
  ds_write_addtid_b32 v227 offset:21120
  s_mul_i32 s76, s78, 44032
  s_mul_i32 s77, s78, 3072
  s_add_u32 s76, s76, s93
  s_add_u32 m0, s77, s94
  s_add_u32 s78, s78, 1
  buffer_load_dwordx4 v7, s[60:63], s76 offen offset:0 lds
  buffer_load_dwordx4 v8, s[60:63], s76 offen offset:1024 lds
  buffer_load_dwordx4 v9, s[60:63], s76 offen offset:2048 lds
  s_and_b32 s78, s78, 7
  s_mov_b32 m0, s20
  v_pk_mul_f32 v[174:175], v[182:183], v[172:173] op_sel:[0,0] op_sel_hi:[0,1]
  v_pk_fma_f32 v[174:175], v[182:183], v[172:173], v[174:175] op_sel:[1,1,0] op_sel_hi:[1,0,1] neg_lo:[1,0,0]
  v_cvt_pk_bf16_f32 v224, v174, v175
  ds_write_addtid_b32 v224 offset:8448
  v_pk_mul_f32 v[214:215], v[192:193], v[166:167] op_sel:[0,0] op_sel_hi:[0,1]
  v_pk_fma_f32 v[214:215], v[192:193], v[166:167], v[214:215] op_sel:[1,1,0] op_sel_hi:[1,0,1] neg_lo:[1,0,0]
  v_cvt_pk_bf16_f32 v225, v214, -v215
  ds_write_addtid_b32 v225 offset:21648
  v_pk_mul_f32 v[176:177], v[184:185], v[172:173] op_sel:[0,0] op_sel_hi:[0,1]
  v_pk_fma_f32 v[176:177], v[184:185], v[172:173], v[176:177] op_sel:[1,1,0] op_sel_hi:[1,0,1] neg_lo:[1,0,0]
  v_cvt_pk_bf16_f32 v226, v176, v177
  ds_write_addtid_b32 v226 offset:8976
  v_pk_mul_f32 v[216:217], v[196:197], v[166:167] op_sel:[0,0] op_sel_hi:[0,1]
  v_pk_fma_f32 v[216:217], v[196:197], v[166:167], v[216:217] op_sel:[1,1,0] op_sel_hi:[1,0,1] neg_lo:[1,0,0]
  v_cvt_pk_bf16_f32 v227, v216, -v217
  ds_write_addtid_b32 v227 offset:22176
  v_pk_mul_f32 v[178:179], v[186:187], v[172:173] op_sel:[0,0] op_sel_hi:[0,1]
  v_pk_fma_f32 v[178:179], v[186:187], v[172:173], v[178:179] op_sel:[1,1,0] op_sel_hi:[1,0,1] neg_lo:[1,0,0]
  v_cvt_pk_bf16_f32 v224, v178, v179
  ds_write_addtid_b32 v224 offset:9504
  v_pk_mul_f32 v[218:219], v[208:209], v[166:167] op_sel:[0,0] op_sel_hi:[0,1]
  v_pk_fma_f32 v[218:219], v[208:209], v[166:167], v[218:219] op_sel:[1,1,0] op_sel_hi:[1,0,1] neg_lo:[1,0,0]
  v_cvt_pk_bf16_f32 v225, v218, -v219
  ds_write_addtid_b32 v225 offset:22704
  v_pk_mul_f32 v[180:181], v[188:189], v[172:173] op_sel:[0,0] op_sel_hi:[0,1]
  v_pk_fma_f32 v[180:181], v[188:189], v[172:173], v[180:181] op_sel:[1,1,0] op_sel_hi:[1,0,1] neg_lo:[1,0,0]
  v_cvt_pk_bf16_f32 v226, v180, v181
  ds_write_addtid_b32 v226 offset:10032
  v_pk_mul_f32 v[220:221], v[160:161], v[168:169] op_sel:[0,0] op_sel_hi:[0,1]
  v_pk_fma_f32 v[220:221], v[160:161], v[168:169], v[220:221] op_sel:[1,1,0] op_sel_hi:[1,0,1] neg_lo:[1,0,0]
  v_cvt_pk_bf16_f32 v227, v220, -v221
  ds_write_addtid_b32 v227 offset:23232
  v_pk_mul_f32 v[182:183], v[174:175], v[172:173] op_sel:[0,0] op_sel_hi:[0,1]
  v_pk_fma_f32 v[182:183], v[174:175], v[172:173], v[182:183] op_sel:[1,1,0] op_sel_hi:[1,0,1] neg_lo:[1,0,0]
  v_cvt_pk_bf16_f32 v224, v182, v183
  ds_write_addtid_b32 v224 offset:10560
  v_pk_mul_f32 v[222:223], v[196:197], v[168:169] op_sel:[0,0] op_sel_hi:[0,1]
  v_pk_fma_f32 v[222:223], v[196:197], v[168:169], v[222:223] op_sel:[1,1,0] op_sel_hi:[1,0,1] neg_lo:[1,0,0]
  v_cvt_pk_bf16_f32 v225, v222, -v223
  ds_write_addtid_b32 v225 offset:23760
  v_pk_mul_f32 v[184:185], v[176:177], v[172:173] op_sel:[0,0] op_sel_hi:[0,1]
  v_pk_fma_f32 v[184:185], v[176:177], v[172:173], v[184:185] op_sel:[1,1,0] op_sel_hi:[1,0,1] neg_lo:[1,0,0]
  v_cvt_pk_bf16_f32 v226, v184, v185
  ds_write_addtid_b32 v226 offset:11088
  v_pk_mul_f32 v[190:191], v[212:213], v[168:169] op_sel:[0,0] op_sel_hi:[0,1]
  v_pk_fma_f32 v[190:191], v[212:213], v[168:169], v[190:191] op_sel:[1,1,0] op_sel_hi:[1,0,1] neg_lo:[1,0,0]
  v_cvt_pk_bf16_f32 v227, v190, -v191
  ds_write_addtid_b32 v227 offset:24288
  v_pk_mul_f32 v[186:187], v[178:179], v[172:173] op_sel:[0,0] op_sel_hi:[0,1]
  v_pk_fma_f32 v[186:187], v[178:179], v[172:173], v[186:187] op_sel:[1,1,0] op_sel_hi:[1,0,1] neg_lo:[1,0,0]
  s_mul_i32 s76, s78, 44032
  s_mul_i32 s77, s78, 3072
  s_add_u32 s76, s76, s93
  s_add_u32 m0, s77, s94
  s_add_u32 s78, s78, 1
  buffer_load_dwordx4 v7, s[60:63], s76 offen offset:0 lds
  buffer_load_dwordx4 v8, s[60:63], s76 offen offset:1024 lds
  buffer_load_dwordx4 v9, s[60:63], s76 offen offset:2048 lds
  s_and_b32 s78, s78, 7
  s_mov_b32 m0, s20
  v_cvt_pk_bf16_f32 v224, v186, v187
  ds_write_addtid_b32 v224 offset:11616
  v_pk_mul_f32 v[194:195], v[216:217], v[168:169] op_sel:[0,0] op_sel_hi:[0,1]
  v_pk_fma_f32 v[194:195], v[216:217], v[168:169], v[194:195] op_sel:[1,1,0] op_sel_hi:[1,0,1] neg_lo:[1,0,0]
  v_cvt_pk_bf16_f32 v225, v194, -v195
  ds_write_addtid_b32 v225 offset:24816
  v_pk_mul_f32 v[188:189], v[180:181], v[172:173] op_sel:[0,0] op_sel_hi:[0,1]
  v_pk_fma_f32 v[188:189], v[180:181], v[172:173], v[188:189] op_sel:[1,1,0] op_sel_hi:[1,0,1] neg_lo:[1,0,0]
  v_cvt_pk_bf16_f32 v226, v188, v189
  ds_write_addtid_b32 v226 offset:12144
  v_pk_mul_f32 v[198:199], v[160:161], v[170:171] op_sel:[0,0] op_sel_hi:[0,1]
  v_pk_fma_f32 v[198:199], v[160:161], v[170:171], v[198:199] op_sel:[1,1,0] op_sel_hi:[1,0,1] neg_lo:[1,0,0]
  v_cvt_pk_bf16_f32 v227, v198, -v199
  ds_write_addtid_b32 v227 offset:25344
  v_pk_mul_f32 v[174:175], v[182:183], v[172:173] op_sel:[0,0] op_sel_hi:[0,1]
  v_pk_fma_f32 v[174:175], v[182:183], v[172:173], v[174:175] op_sel:[1,1,0] op_sel_hi:[1,0,1] neg_lo:[1,0,0]
  v_cvt_pk_bf16_f32 v224, v174, v175
  ds_write_addtid_b32 v224 offset:12672
  v_pk_mul_f32 v[210:211], v[212:213], v[170:171] op_sel:[0,0] op_sel_hi:[0,1]
  v_pk_fma_f32 v[210:211], v[212:213], v[170:171], v[210:211] op_sel:[1,1,0] op_sel_hi:[1,0,1] neg_lo:[1,0,0]
  v_cvt_pk_bf16_f32 v225, v210, -v211
  ds_write_addtid_b32 v225 offset:25872
  v_pk_mul_f32 v[176:177], v[184:185], v[172:173] op_sel:[0,0] op_sel_hi:[0,1]
  v_pk_fma_f32 v[176:177], v[184:185], v[172:173], v[176:177] op_sel:[1,1,0] op_sel_hi:[1,0,1] neg_lo:[1,0,0]
  v_cvt_pk_bf16_f32 v226, v176, v177
  ds_write_addtid_b32 v226 offset:13200
  v_pk_mul_f32 v[214:215], v[220:221], v[170:171] op_sel:[0,0] op_sel_hi:[0,1]
  v_pk_fma_f32 v[214:215], v[220:221], v[170:171], v[214:215] op_sel:[1,1,0] op_sel_hi:[1,0,1] neg_lo:[1,0,0]
  v_cvt_pk_bf16_f32 v227, v214, -v215
  ds_write_addtid_b32 v227 offset:26400
  v_pk_mul_f32 v[178:179], v[186:187], v[172:173] op_sel:[0,0] op_sel_hi:[0,1]
  v_pk_fma_f32 v[178:179], v[186:187], v[172:173], v[178:179] op_sel:[1,1,0] op_sel_hi:[1,0,1] neg_lo:[1,0,0]
  v_cvt_pk_bf16_f32 v224, v178, v179
  ds_write_addtid_b32 v224 offset:13728
  v_pk_mul_f32 v[192:193], v[190:191], v[170:171] op_sel:[0,0] op_sel_hi:[0,1]
  v_pk_fma_f32 v[192:193], v[190:191], v[170:171], v[192:193] op_sel:[1,1,0] op_sel_hi:[1,0,1] neg_lo:[1,0,0]
  v_cvt_pk_bf16_f32 v225, v192, -v193
  s_waitcnt vmcnt(12)
  ds_read_b64_tr_b16 v[200:201], v252 offset:0
  ds_read_b64_tr_b16 v[202:203], v252 offset:1024
  ds_read_b64_tr_b16 v[204:205], v253 offset:0
  ds_read_b64_tr_b16 v[206:207], v253 offset:1024
  ds_write_addtid_b32 v225 offset:26928
  v_pk_mul_f32 v[180:181], v[188:189], v[172:173] op_sel:[0,0] op_sel_hi:[0,1]
  v_pk_fma_f32 v[180:181], v[188:189], v[172:173], v[180:181] op_sel:[1,1,0] op_sel_hi:[1,0,1] neg_lo:[1,0,0]
  v_cvt_pk_bf16_f32 v226, v180, v181
  ds_write_addtid_b32 v226 offset:14256
  v_pk_mul_f32 v[218:219], v[198:199], v[170:171] op_sel:[0,0] op_sel_hi:[0,1]
  v_pk_fma_f32 v[218:219], v[198:199], v[170:171], v[218:219] op_sel:[1,1,0] op_sel_hi:[1,0,1] neg_lo:[1,0,0]
  v_cvt_pk_bf16_f32 v227, v218, -v219
  ds_write_addtid_b32 v227 offset:27456
  v_pk_mul_f32 v[182:183], v[174:175], v[172:173] op_sel:[0,0] op_sel_hi:[0,1]
  s_waitcnt lgkmcnt(5)
  buffer_store_dwordx4 v[200:203], v2, s[56:59], s97 offen offset:0 sc1
  v_pk_fma_f32 v[182:183], v[174:175], v[172:173], v[182:183] op_sel:[1,1,0] op_sel_hi:[1,0,1] neg_lo:[1,0,0]
  v_cvt_pk_bf16_f32 v224, v182, v183
  ds_write_addtid_b32 v224 offset:14784
  v_pk_mul_f32 v[184:185], v[176:177], v[172:173] op_sel:[0,0] op_sel_hi:[0,1]
  v_pk_fma_f32 v[184:185], v[176:177], v[172:173], v[184:185] op_sel:[1,1,0] op_sel_hi:[1,0,1] neg_lo:[1,0,0]
  v_cvt_pk_bf16_f32 v225, v184, v185
  ds_write_addtid_b32 v225 offset:15312
  v_pk_mul_f32 v[186:187], v[178:179], v[172:173] op_sel:[0,0] op_sel_hi:[0,1]
  v_pk_fma_f32 v[186:187], v[178:179], v[172:173], v[186:187] op_sel:[1,1,0] op_sel_hi:[1,0,1] neg_lo:[1,0,0]
  v_cvt_pk_bf16_f32 v226, v186, v187
  ds_write_addtid_b32 v226 offset:15840
  v_pk_mul_f32 v[188:189], v[180:181], v[172:173] op_sel:[0,0] op_sel_hi:[0,1]
  s_waitcnt lgkmcnt(6)
  buffer_store_dwordx4 v[204:207], v2, s[56:59], s97 offen offset:1024 sc1
  v_pk_fma_f32 v[188:189], v[180:181], v[172:173], v[188:189] op_sel:[1,1,0] op_sel_hi:[1,0,1] neg_lo:[1,0,0]
  v_cvt_pk_bf16_f32 v227, v188, v189
  ds_write_addtid_b32 v227 offset:16368
  s_mul_i32 s79, s51, 2080
  s_mul_i32 s76, s78, 44032
  s_mul_i32 s77, s78, 3072
  s_add_u32 s76, s76, s93
  s_add_u32 m0, s77, s94
  s_add_u32 s78, s78, 1
  buffer_load_dwordx4 v7, s[60:63], s76 offen offset:0 lds
  buffer_load_dwordx4 v8, s[60:63], s76 offen offset:1024 lds
  buffer_load_dwordx4 v9, s[60:63], s76 offen offset:2048 lds
  s_and_b32 s78, s78, 7
  s_add_u32 s79, s79, 154624
  s_lshl_b32 s12, s50, 6
  v_add_u32 v27, s12, v1
  v_lshlrev_b32 v244, 5, v12
  v_lshlrev_b32 v173, 4, v13
  v_sub_u32 v174, v173, v244
  v_lshl_add_u32 v244, v13, 3, v244
  s_mul_i32 s12, s51, 4608
  s_lshl_b32 s13, s50, 8
  s_add_u32 s12, s12, s13
  s_add_u32 s12, s12, 17120
  v_add_u32 v11, s12, v174
  v_and_b32 v174, 1, v1
  v_mul_u32_u24 v174, 4160, v174
  v_bfe_u32 v175, v1, 1, 3
  v_lshl_add_u32 v174, v175, 2, v174
  s_mul_i32 s21, s51, 8320
  s_add_u32 s21, s21, s13
  v_add3_u32 v10, v174, v173, s21
  s_lshl_b32 s13, s50, 4
  v_add_u32 v160, s13, v12
  v_mov_b32 v161, v13
  v_mul_u32_u24 v12, 528, v12
  s_mul_i32 s12, s51, 27984
  v_add3_u32 v12, v12, v173, s12
  s_mul_i32 s13, s50, 8448
  v_add_u32 v13, s13, v12
  v_lshlrev_b32 v14, 3, v160
  v_lshl_add_u32 v14, v161, 2, v14
  v_lshlrev_b32 v173, 2, v160
  v_add_u32 v173, 0x100, v173
  v_cmp_eq_u32 vcc, 2, v161
  v_lshlrev_b32 v174, 1, v160
  v_add_u32 v174, 0x180, v174
  v_cndmask_b32 v14, v14, v173, vcc
  v_cmp_eq_u32 vcc, 3, v161
  v_mov_b32 v173, 2
  v_mov_b32 v175, 64
  v_cndmask_b32 v14, v14, v174, vcc
  s_mul_i32 s76, s78, 44032
  s_mul_i32 s77, s78, 3072
  s_add_u32 s76, s76, s93
  s_add_u32 m0, s77, s94
  s_add_u32 s78, s78, 1
  buffer_load_dwordx4 v7, s[60:63], s76 offen offset:0 lds
  buffer_load_dwordx4 v8, s[60:63], s76 offen offset:1024 lds
  buffer_load_dwordx4 v9, s[60:63], s76 offen offset:2048 lds
  s_and_b32 s78, s78, 7
  v_cndmask_b32 v173, v173, v175, vcc
  v_add_u32 v15, v14, v173
  v_lshl_add_u32 v14, v14, 1, s79
  v_lshl_add_u32 v15, v15, 1, s79
  v_lshl_add_u32 v16, v161, 7, v160
  v_add_u32 v16, 0x200, v16
  v_lshl_add_u32 v16, v16, 1, s79
  v_lshrrev_b32 v252, 5, v1
  v_and_b32 v253, 31, v1
  v_lshlrev_b32 v245, 10, v253
  v_lshl_add_u32 v245, v252, 4, v245
  v_lshlrev_b32 v25, 15, v252
  v_lshl_add_u32 v25, v253, 4, v25
  v_mul_u32_u24 v251, 4608, v252
  v_lshl_add_u32 v251, v253, 4, v251
  s_lshr_b32 s12, s8, 5
  s_and_b32 s12, s12, 3
  s_lshl2_add_u32 s12, s12, s3
  s_lshl_b32 s12, s12, 8
  s_add_u32 s12, s12, 13238272
  buffer_load_dword v23, v18, s[56:59], 0 offen sc1
  v_lshl_add_u32 v19, v1, 2, s12
  s_lshl_b32 s12, s3, 19
  s_lshr_b32 s13, s8, 2
  s_lshl_b32 s13, s13, 9
  s_add_u32 s12, s12, s13
  s_and_b32 s13, s8, 3
  s_lshl2_add_u32 s89, s13, s12
  s_lshl_b32 s12, s3, 10
  s_sub_u32 s12, 19838, s12
  v_lshlrev_b32 v26, 1, v1
  v_sub_u32 v26, s12, v26
  s_mul_i32 s12, s3, 22
  s_lshl_b32 s13, s10, 7
  s_add_u32 s12, s12, s13
  s_lshl_b32 s12, s12, 4
  s_add_u32 s12, s12, 12976128
  v_min_u32 v20, 21, v1
  v_lshl_add_u32 v20, v20, 4, s12
  v_lshlrev_b32 v254, 2, v27
  v_add_u32 v233, s79, v254
  v_subrev_u32 v232, 2, v233
  v_mov_b32 v253, s79
  v_cmp_eq_u32 vcc, 0, v27
  v_add_u32 v253, 2048, v253
  v_lshlrev_b32 v254, 1, v27
  v_cndmask_b32 v232, v232, v253, vcc
  v_cvt_f32_u32 v254, v254
  s_sub_u32 s14, s79, 34048
  v_add_f32 v234, 0x437f0000, v254
  v_add_f32 v235, 0x43800000, v254
  v_add_f32 v236, 0x43808000, v254
  v_cvt_pk_bf16_f32 v235, v234, v235
  v_cvt_pk_bf16_f32 v236, v236, v236
  v_and_b32 v234, 0xffff, v235
  v_lshrrev_b32 v235, 16, v235
  v_lshrrev_b32 v236, 16, v236
  v_lshl_add_u32 v234, v234, 1, s14
  v_lshl_add_u32 v235, v235, 1, s14
  v_lshl_add_u32 v236, v236, 1, s14
  v_add_f32 v237, 0x43ff8000, v254
  v_add_f32 v238, 0x44000000, v254
  v_add_f32 v239, 0x44004000, v254
  v_cvt_pk_bf16_f32 v238, v237, v238
  v_cvt_pk_bf16_f32 v239, v239, v239
  v_and_b32 v237, 0xffff, v238
  v_lshrrev_b32 v238, 16, v238
  v_lshrrev_b32 v239, 16, v239
  v_lshl_add_u32 v237, v237, 1, s14
  v_lshl_add_u32 v238, v238, 1, s14
  v_lshl_add_u32 v239, v239, 1, s14
  v_add_f32 v240, 0x447fc000, v254
  v_add_f32 v241, 0x44800000, v254
  v_add_f32 v242, 0x44802000, v254
  v_cvt_pk_bf16_f32 v241, v240, v241
  v_cvt_pk_bf16_f32 v242, v242, v242
  v_and_b32 v240, 0xffff, v241
  v_lshrrev_b32 v241, 16, v241
  v_lshrrev_b32 v242, 16, v242
  v_lshl_add_u32 v240, v240, 1, s14
  v_lshl_add_u32 v241, v241, 1, s14
  v_lshl_add_u32 v242, v242, 1, s14
  s_lshl2_add_u32 s12, s6, s3
  s_waitcnt vmcnt(7)
  s_mov_b64 exec, 1
  buffer_store_dword v5, v6, s[56:59], s98 offen sc1
  s_mov_b64 exec, -1
  s_waitcnt vmcnt(1)
  v_cmp_ne_u32 vcc, s11, v23
  s_cbranch_vccnz L_spin0
L_back0:
  s_mul_i32 s12, s12, 86
  buffer_load_dwordx4 v[32:35], v2, s[56:59], s80 offen offset:0 sc1
  s_mul_i32 s13, s7, 6
  s_add_u32 s12, s12, s13
  s_lshl_b32 s12, s12, 10
  s_add_u32 s84, s12, 6291456
  s_lshl_b32 s12, s3, 11
  s_add_u32 s12, s12, 98304
  buffer_load_dwordx4 v[36:39], v2, s[56:59], s80 offen offset:1024 sc1
  v_add_u32 v250, s12, v250
  v_add_u32 v249, s12, v2
  v_lshrrev_b32 v248, 2, v1
  v_lshlrev_b32 v248, 12, v248
  v_and_b32 v160, 3, v1
  v_lshl_add_u32 v248, v160, 4, v248
  buffer_load_dwordx4 v[40:43], v2, s[56:59], s80 offen offset:2048 sc1
  s_lshl1_add_u32 s12, s8, s51
  s_lshl1_add_u32 s12, s12, s50
  s_lshl_b32 s12, s12, 11
  s_add_u32 s88, s12, 4194304
  s_mul_i32 s12, s10, 88
  s_mul_i32 s13, s3, 22
  buffer_load_dwordx4 v[44:47], v2, s[56:59], s80 offen offset:3072 sc1
  s_add_u32 s80, s80, 4096
  s_add_u32 s12, s12, s13
  s_lshl_b32 s12, s12, 11
  s_add_u32 s81, s12, 14680064
  s_lshl_b32 s12, s50, 10
  v_add_u32 v246, s12, v2
  s_lshl4_add_u32 s12, s6, s7
  buffer_load_dwordx4 v[48:51], v2, s[56:59], s80 offen offset:0 sc1
  s_lshl2_add_u32 s12, s12, s3
  s_lshl_b32 s12, s12, 5
  s_add_u32 s86, s12, 12713984
  s_add_u32 s22, s84, 2048
  s_add_u32 s23, s84, 4096
  s_cmp_lt_u32 s7, 15
  s_cselect_b32 s84, s84, 1879048192
  buffer_load_dwordx4 v[52:55], v2, s[56:59], s80 offen offset:1024 sc1
  s_cmp_lt_u32 s7, 14
  s_cselect_b32 s22, s22, 1879048192
  s_cselect_b32 s23, s23, 1879048192
  s_mul_i32 s14, s3, 240306
  s_lshr_b32 s14, s14, 16
  s_lshr_b32 s12, s9, 1
  s_lshl_b32 s12, s12, 5
  s_and_b32 s13, s9, 1
  buffer_load_dwordx4 v[56:59], v2, s[56:59], s80 offen offset:2048 sc1
  s_add_u32 s12, s12, s13
  s_lshl_b32 s12, s12, 6
  s_add_u32 s12, s12, 12713984
  v_lshrrev_b32 v160, 1, v1
  v_min_u32 v160, 4, v160
  v_add_u32 v160, s14, v160
  buffer_load_dwordx4 v[60:63], v2, s[56:59], s80 offen offset:3072 sc1
  s_add_u32 s80, s80, 4096
  v_min_u32 v160, 14, v160
  v_and_b32 v21, 1, v1
  v_lshl_add_u32 v160, v160, 2, v21
  v_lshl_add_u32 v21, v160, 5, s12
  s_lshl1_add_u32 s14, s9, s51
  s_xor_b32 s13, s14, 1
  buffer_load_dwordx4 v[64:67], v2, s[56:59], s80 offen offset:0 sc1
  s_mul_i32 s14, s14, 86
  s_mul_i32 s13, s13, 86
  s_mul_i32 s12, s3, 22
  s_add_u32 s12, s12, 6144
  s_add_u32 s14, s14, s12
  s_add_u32 s13, s13, s12
  buffer_load_dwordx4 v[68:71], v2, s[56:59], s80 offen offset:1024 sc1
  s_lshl_b32 s82, s14, 10
  s_lshl_b32 s83, s13, 10
  s_lshl_b32 s12, s3, 12
  s_add_u32 s12, s12, 49152
  v_add_u32 v247, s12, v2
  s_lshl2_add_u32 s12, s8, s3
  buffer_load_dwordx4 v[72:75], v2, s[56:59], s80 offen offset:2048 sc1
  s_lshl_b32 s12, s12, 5
  s_add_u32 s87, s12, 12845056
  s_lshr_b32 s13, s9, 4
  s_add_u32 s14, s95, s13
  s_lshl_b32 s14, s14, 5
  s_add_u32 s14, s14, 12845056
  buffer_load_dwordx4 v[76:79], v2, s[56:59], s80 offen offset:3072 sc1
  s_add_u32 s80, s80, 4096
  v_min_u32 v22, 31, v1
  v_lshl_add_u32 v22, v22, 6, s14
  s_lshl_b32 s14, s95, 11
  s_lshl1_add_u32 s13, s9, s51
  s_lshl_b32 s13, s13, 6
  s_add_u32 s14, s14, s13
  buffer_load_dwordx4 v[80:83], v2, s[56:59], s80 offen offset:0 sc1
  s_add_u32 s90, s14, 4194304
  s_add_u32 s25, s90, 65536
  s_lshl_b32 s12, s9, 16
  s_lshl_b32 s13, s51, 15
  s_add_u32 s12, s12, s13
  s_add_u32 s91, s12, s95
  s_waitcnt lgkmcnt(0)
  s_barrier
  .p2alignl 3, 0xbf800000
  ds_read_b64_tr_b16 v[208:209], v3 offset:0
  ds_read_b64_tr_b16 v[210:211], v3 offset:768
  ds_read_b64_tr_b16 v[212:213], v3 offset:64
  ds_read_b64_tr_b16 v[214:215], v3 offset:832
  ds_read_b64_tr_b16 v[216:217], v3 offset:128
  ds_read_b64_tr_b16 v[218:219], v3 offset:896
  ds_read_b64_tr_b16 v[220:221], v3 offset:3072
  ds_read_b64_tr_b16 v[222:223], v3 offset:3840
  v_mfma_f32_32x32x16_bf16 v[160:175], a[240:243], v[28:31], 0
  s_mov_b32 m0, s21
  buffer_load_dwordx4 v[84:87], v2, s[56:59], s80 offen offset:1024 sc1
  v_mfma_f32_32x32x16_bf16 v[176:191], a[244:247], v[28:31], 0
  v_mfma_f32_32x32x16_bf16 v[192:207], a[248:251], v[28:31], 0
  ds_read_b64_tr_b16 v[224:225], v3 offset:3136
  ds_read_b64_tr_b16 v[226:227], v3 offset:3904
  buffer_load_dwordx4 v[88:91], v2, s[56:59], s80 offen offset:2048 sc1
  s_waitcnt lgkmcnt(6)
  s_waitcnt vmcnt(14)
  v_mfma_f32_32x32x16_bf16 v[160:175], v[208:211], v[32:35], v[160:175]
  ds_read_b64_tr_b16 v[228:229], v3 offset:3200
  ds_read_b64_tr_b16 v[230:231], v3 offset:3968
  v_mfma_f32_32x32x16_bf16 v[176:191], v[212:215], v[32:35], v[176:191]
  ds_read_b64_tr_b16 v[208:209], v3 offset:6144
  ds_read_b64_tr_b16 v[210:211], v3 offset:6912
  buffer_load_dwordx4 v[92:95], v2, s[56:59], s80 offen offset:3072 sc1
  s_add_u32 s80, s80, 4096
  s_waitcnt lgkmcnt(6)
  v_mfma_f32_32x32x16_bf16 v[192:207], v[216:219], v[32:35], v[192:207]
  ds_read_b64_tr_b16 v[212:213], v3 offset:6208
  ds_read_b64_tr_b16 v[214:215], v3 offset:6976
  s_waitcnt vmcnt(14)
  v_mfma_f32_32x32x16_bf16 v[160:175], v[220:223], v[36:39], v[160:175]
  ds_read_b64_tr_b16 v[216:217], v3 offset:6272
  ds_read_b64_tr_b16 v[218:219], v3 offset:7040
  buffer_load_dwordx4 v[96:99], v2, s[56:59], s80 offen offset:0 sc1
  s_waitcnt lgkmcnt(6)
  v_mfma_f32_32x32x16_bf16 v[176:191], v[224:227], v[36:39], v[176:191]
  ds_read_b64_tr_b16 v[220:221], v3 offset:9216
  ds_read_b64_tr_b16 v[222:223], v3 offset:9984
  v_mfma_f32_32x32x16_bf16 v[192:207], v[228:231], v[36:39], v[192:207]
  ds_read_b64_tr_b16 v[224:225], v3 offset:9280
  ds_read_b64_tr_b16 v[226:227], v3 offset:10048
  buffer_load_dwordx4 v[100:103], v2, s[56:59], s80 offen offset:1024 sc1
  s_waitcnt lgkmcnt(6)
  s_waitcnt vmcnt(15)
  v_mfma_f32_32x32x16_bf16 v[160:175], v[208:211], v[40:43], v[160:175]
  ds_read_b64_tr_b16 v[228:229], v3 offset:9344
  ds_read_b64_tr_b16 v[230:231], v3 offset:10112
  v_mfma_f32_32x32x16_bf16 v[176:191], v[212:215], v[40:43], v[176:191]
  ds_read_b64_tr_b16 v[208:209], v3 offset:12288
  ds_read_b64_tr_b16 v[210:211], v3 offset:13056
  buffer_load_dwordx4 v[104:107], v2, s[56:59], s80 offen offset:2048 sc1
  s_waitcnt lgkmcnt(6)
  v_mfma_f32_32x32x16_bf16 v[192:207], v[216:219], v[40:43], v[192:207]
  ds_read_b64_tr_b16 v[212:213], v3 offset:12352
  ds_read_b64_tr_b16 v[214:215], v3 offset:13120
  s_waitcnt vmcnt(15)
  v_mfma_f32_32x32x16_bf16 v[160:175], v[220:223], v[44:47], v[160:175]
  ds_read_b64_tr_b16 v[216:217], v3 offset:12416
  ds_read_b64_tr_b16 v[218:219], v3 offset:13184
  buffer_load_dwordx4 v[108:111], v2, s[56:59], s80 offen offset:3072 sc1
  s_add_u32 s80, s80, 4096
  s_waitcnt lgkmcnt(6)
  v_mfma_f32_32x32x16_bf16 v[176:191], v[224:227], v[44:47], v[176:191]
  ds_read_b64_tr_b16 v[220:221], v3 offset:15360
  ds_read_b64_tr_b16 v[222:223], v3 offset:16128
  v_mfma_f32_32x32x16_bf16 v[192:207], v[228:231], v[44:47], v[192:207]
  ds_read_b64_tr_b16 v[224:225], v3 offset:15424
  ds_read_b64_tr_b16 v[226:227], v3 offset:16192
  buffer_load_dwordx4 v[112:115], v2, s[56:59], s80 offen offset:0 sc1
  s_waitcnt lgkmcnt(6)
  s_waitcnt vmcnt(16)
  v_mfma_f32_32x32x16_bf16 v[160:175], v[208:211], v[48:51], v[160:175]
  ds_read_b64_tr_b16 v[228:229], v3 offset:15488
  ds_read_b64_tr_b16 v[230:231], v3 offset:16256
  v_mfma_f32_32x32x16_bf16 v[176:191], v[212:215], v[48:51], v[176:191]
  ds_read_b64_tr_b16 v[208:209], v3 offset:18432
  ds_read_b64_tr_b16 v[210:211], v3 offset:19200
  buffer_load_dwordx4 v[116:119], v2, s[56:59], s80 offen offset:1024 sc1
  s_waitcnt lgkmcnt(6)
  v_mfma_f32_32x32x16_bf16 v[192:207], v[216:219], v[48:51], v[192:207]
  ds_read_b64_tr_b16 v[212:213], v3 offset:18496
  ds_read_b64_tr_b16 v[214:215], v3 offset:19264
  s_waitcnt vmcnt(16)
  v_mfma_f32_32x32x16_bf16 v[160:175], v[220:223], v[52:55], v[160:175]
  ds_read_b64_tr_b16 v[216:217], v3 offset:18560
  ds_read_b64_tr_b16 v[218:219], v3 offset:19328
  buffer_load_dwordx4 v[120:123], v2, s[56:59], s80 offen offset:2048 sc1
  s_waitcnt lgkmcnt(6)
  v_mfma_f32_32x32x16_bf16 v[176:191], v[224:227], v[52:55], v[176:191]
  ds_read_b64_tr_b16 v[220:221], v3 offset:21504
  ds_read_b64_tr_b16 v[222:223], v3 offset:22272
  v_mfma_f32_32x32x16_bf16 v[192:207], v[228:231], v[52:55], v[192:207]
  ds_read_b64_tr_b16 v[224:225], v3 offset:21568
  ds_read_b64_tr_b16 v[226:227], v3 offset:22336
  buffer_load_dwordx4 v[124:127], v2, s[56:59], s80 offen offset:3072 sc1
  s_add_u32 s80, s80, 4096
  s_waitcnt lgkmcnt(6)
  s_waitcnt vmcnt(17)
  v_mfma_f32_32x32x16_bf16 v[160:175], v[208:211], v[56:59], v[160:175]
  ds_read_b64_tr_b16 v[228:229], v3 offset:21632
  ds_read_b64_tr_b16 v[230:231], v3 offset:22400
  v_mfma_f32_32x32x16_bf16 v[176:191], v[212:215], v[56:59], v[176:191]
  ds_read_b64_tr_b16 v[208:209], v3 offset:24576
  ds_read_b64_tr_b16 v[210:211], v3 offset:25344
  buffer_load_dwordx4 v[128:131], v2, s[56:59], s80 offen offset:0 sc1
  s_waitcnt lgkmcnt(6)
  v_mfma_f32_32x32x16_bf16 v[192:207], v[216:219], v[56:59], v[192:207]
  ds_read_b64_tr_b16 v[212:213], v3 offset:24640
  ds_read_b64_tr_b16 v[214:215], v3 offset:25408
  s_waitcnt vmcnt(17)
  v_mfma_f32_32x32x16_bf16 v[160:175], v[220:223], v[60:63], v[160:175]
  buffer_load_dword v23, v19, s[56:59], 0 offen sc1
  ds_read_b64_tr_b16 v[216:217], v3 offset:24704
  ds_read_b64_tr_b16 v[218:219], v3 offset:25472
  buffer_load_dwordx4 v[132:135], v2, s[56:59], s80 offen offset:1024 sc1
  s_waitcnt lgkmcnt(6)
  v_mfma_f32_32x32x16_bf16 v[176:191], v[224:227], v[60:63], v[176:191]
  ds_read_b64_tr_b16 v[220:221], v3 offset:27648
  ds_read_b64_tr_b16 v[222:223], v3 offset:28416
  v_mfma_f32_32x32x16_bf16 v[192:207], v[228:231], v[60:63], v[192:207]
  ds_read_b64_tr_b16 v[224:225], v3 offset:27712
  ds_read_b64_tr_b16 v[226:227], v3 offset:28480
  buffer_load_dwordx4 v[136:139], v2, s[56:59], s80 offen offset:2048 sc1
  s_waitcnt lgkmcnt(6)
  s_waitcnt vmcnt(19)
  v_mfma_f32_32x32x16_bf16 v[160:175], v[208:211], v[64:67], v[160:175]
  ds_read_b64_tr_b16 v[228:229], v3 offset:27776
  ds_read_b64_tr_b16 v[230:231], v3 offset:28544
  v_mfma_f32_32x32x16_bf16 v[176:191], v[212:215], v[64:67], v[176:191]
  ds_read_b64_tr_b16 v[208:209], v3 offset:30720
  ds_read_b64_tr_b16 v[210:211], v3 offset:31488
  buffer_load_dwordx4 v[140:143], v2, s[56:59], s80 offen offset:3072 sc1
  s_add_u32 s80, s80, 4096
  s_waitcnt lgkmcnt(6)
  v_mfma_f32_32x32x16_bf16 v[192:207], v[216:219], v[64:67], v[192:207]
  ds_read_b64_tr_b16 v[212:213], v3 offset:30784
  ds_read_b64_tr_b16 v[214:215], v3 offset:31552
  s_waitcnt vmcnt(19)
  v_mfma_f32_32x32x16_bf16 v[160:175], v[220:223], v[68:71], v[160:175]
  ds_read_b64_tr_b16 v[216:217], v3 offset:30848
  ds_read_b64_tr_b16 v[218:219], v3 offset:31616
  buffer_load_dwordx4 v[144:147], v2, s[56:59], s80 offen offset:0 sc1
  s_waitcnt lgkmcnt(6)
  v_mfma_f32_32x32x16_bf16 v[176:191], v[224:227], v[68:71], v[176:191]
  ds_read_b64_tr_b16 v[220:221], v3 offset:33792
  ds_read_b64_tr_b16 v[222:223], v3 offset:34560
  v_mfma_f32_32x32x16_bf16 v[192:207], v[228:231], v[68:71], v[192:207]
  ds_read_b64_tr_b16 v[224:225], v3 offset:33856
  ds_read_b64_tr_b16 v[226:227], v3 offset:34624
  buffer_load_dwordx4 v[148:151], v2, s[56:59], s80 offen offset:1024 sc1
  s_waitcnt lgkmcnt(6)
  s_waitcnt vmcnt(20)
  v_mfma_f32_32x32x16_bf16 v[160:175], v[208:211], v[72:75], v[160:175]
  ds_read_b64_tr_b16 v[228:229], v3 offset:33920
  ds_read_b64_tr_b16 v[230:231], v3 offset:34688
  v_mfma_f32_32x32x16_bf16 v[176:191], v[212:215], v[72:75], v[176:191]
  buffer_load_dword v24, v20, s[56:59], 0 offen sc1
  ds_read_b64_tr_b16 v[208:209], v3 offset:36864
  ds_read_b64_tr_b16 v[210:211], v3 offset:37632
  buffer_load_dwordx4 v[152:155], v2, s[56:59], s80 offen offset:2048 sc1
  s_waitcnt lgkmcnt(6)
  v_mfma_f32_32x32x16_bf16 v[192:207], v[216:219], v[72:75], v[192:207]
  ds_read_b64_tr_b16 v[212:213], v3 offset:36928
  ds_read_b64_tr_b16 v[214:215], v3 offset:37696
  s_waitcnt vmcnt(21)
  v_mfma_f32_32x32x16_bf16 v[160:175], v[220:223], v[76:79], v[160:175]
  ds_read_b64_tr_b16 v[216:217], v3 offset:36992
  ds_read_b64_tr_b16 v[218:219], v3 offset:37760
  buffer_load_dwordx4 v[156:159], v2, s[56:59], s80 offen offset:3072 sc1
  s_add_u32 s80, s80, 4096
  s_waitcnt lgkmcnt(6)
  v_mfma_f32_32x32x16_bf16 v[176:191], v[224:227], v[76:79], v[176:191]
  ds_read_b64_tr_b16 v[220:221], v3 offset:39936
  ds_read_b64_tr_b16 v[222:223], v3 offset:40704
  v_mfma_f32_32x32x16_bf16 v[192:207], v[228:231], v[76:79], v[192:207]
  ds_read_b64_tr_b16 v[224:225], v3 offset:40000
  ds_read_b64_tr_b16 v[226:227], v3 offset:40768
  s_waitcnt lgkmcnt(6)
  s_waitcnt vmcnt(21)
  v_mfma_f32_32x32x16_bf16 v[160:175], v[208:211], v[80:83], v[160:175]
  ds_read_b64_tr_b16 v[228:229], v3 offset:40064
  ds_read_b64_tr_b16 v[230:231], v3 offset:40832
  v_mfma_f32_32x32x16_bf16 v[176:191], v[212:215], v[80:83], v[176:191]
  v_xor_b32 v18, 0x400, v246
  v_add_u32 v7, 0x400, v10
  v_add_u32 v8, 0x800, v10
  v_add_u32 v9, 0xc00, v10
  ds_read_b64_tr_b16 v[208:209], v3 offset:43008
  ds_read_b64_tr_b16 v[210:211], v3 offset:43776
  s_waitcnt lgkmcnt(6)
  v_mfma_f32_32x32x16_bf16 v[192:207], v[216:219], v[80:83], v[192:207]
  ds_read_b64_tr_b16 v[212:213], v3 offset:43072
  ds_read_b64_tr_b16 v[214:215], v3 offset:43840
  s_waitcnt vmcnt(20)
  v_mfma_f32_32x32x16_bf16 v[160:175], v[220:223], v[84:87], v[160:175]
  ds_read_b64_tr_b16 v[216:217], v3 offset:43136
  ds_read_b64_tr_b16 v[218:219], v3 offset:43904
  s_waitcnt lgkmcnt(6)
  v_mfma_f32_32x32x16_bf16 v[176:191], v[224:227], v[84:87], v[176:191]
  ds_read_b64_tr_b16 v[220:221], v3 offset:46080
  ds_read_b64_tr_b16 v[222:223], v3 offset:46848
  v_mfma_f32_32x32x16_bf16 v[192:207], v[228:231], v[84:87], v[192:207]
  ds_read_b64_tr_b16 v[224:225], v3 offset:46144
  ds_read_b64_tr_b16 v[226:227], v3 offset:46912
  s_waitcnt lgkmcnt(6)
  s_waitcnt vmcnt(19)
  v_mfma_f32_32x32x16_bf16 v[160:175], v[208:211], v[88:91], v[160:175]
  ds_read_b64_tr_b16 v[228:229], v3 offset:46208
  ds_read_b64_tr_b16 v[230:231], v3 offset:46976
  v_mfma_f32_32x32x16_bf16 v[176:191], v[212:215], v[88:91], v[176:191]
  s_waitcnt vmcnt(8)
  v_cmp_ne_u32 vcc, s11, v23
  s_cbranch_vccnz L_spin1
L_back1:
  ds_read_b64_tr_b16 v[208:209], v4 offset:0
  ds_read_b64_tr_b16 v[210:211], v4 offset:768
  buffer_load_dword a232, v25, s[56:59], s89 offen sc1
  s_add_u32 s89, s89, 65536
  s_waitcnt lgkmcnt(6)
  v_mfma_f32_32x32x16_bf16 v[192:207], v[216:219], v[88:91], v[192:207]
  ds_read_b64_tr_b16 v[212:213], v4 offset:64
  ds_read_b64_tr_b16 v[214:215], v4 offset:832
  v_mfma_f32_32x32x16_bf16 v[160:175], v[220:223], v[92:95], v[160:175]
  ds_read_b64_tr_b16 v[216:217], v4 offset:128
  ds_read_b64_tr_b16 v[218:219], v4 offset:896
  buffer_load_dword a233, v25, s[56:59], s89 offen sc1
  s_add_u32 s89, s89, 65536
  s_waitcnt lgkmcnt(6)
  v_mfma_f32_32x32x16_bf16 v[176:191], v[224:227], v[92:95], v[176:191]
  ds_read_b64_tr_b16 v[220:221], v4 offset:3072
  ds_read_b64_tr_b16 v[222:223], v4 offset:3840
  v_mfma_f32_32x32x16_bf16 v[192:207], v[228:231], v[92:95], v[192:207]
  ds_read_b64_tr_b16 v[224:225], v4 offset:3136
  ds_read_b64_tr_b16 v[226:227], v4 offset:3904
  buffer_load_dword a234, v25, s[56:59], s89 offen sc1
  s_add_u32 s89, s89, 65536
  s_waitcnt lgkmcnt(6)
  v_mfma_f32_32x32x16_bf16 v[160:175], v[208:211], v[96:99], v[160:175]
  ds_read_b64_tr_b16 v[228:229], v4 offset:3200
  ds_read_b64_tr_b16 v[230:231], v4 offset:3968
  v_mfma_f32_32x32x16_bf16 v[176:191], v[212:215], v[96:99], v[176:191]
  ds_read_b64_tr_b16 v[208:209], v4 offset:6144
  ds_read_b64_tr_b16 v[210:211], v4 offset:6912
  buffer_load_dword a235, v25, s[56:59], s89 offen sc1
  s_add_u32 s89, s89, 65536
  s_waitcnt lgkmcnt(6)
  v_mfma_f32_32x32x16_bf16 v[192:207], v[216:219], v[96:99], v[192:207]
  ds_read_b64_tr_b16 v[212:213], v4 offset:9216
  ds_read_b64_tr_b16 v[214:215], v4 offset:9984
  v_mfma_f32_32x32x16_bf16 v[160:175], v[220:223], v[100:103], v[160:175]
  ds_read_b64_tr_b16 v[216:217], v4 offset:12288
  ds_read_b64_tr_b16 v[218:219], v4 offset:13056
  buffer_load_dword a236, v25, s[56:59], s89 offen sc1
  s_add_u32 s89, s89, 65536
  s_waitcnt lgkmcnt(6)
  v_mfma_f32_32x32x16_bf16 v[176:191], v[224:227], v[100:103], v[176:191]
  s_waitcnt vmcnt(7)
  v_cmp_ne_u32 vcc, s11, v24
  s_cbranch_vccnz L_spin2
L_back2:
  ds_read_b64_tr_b16 v[220:221], v4 offset:15360
  ds_read_b64_tr_b16 v[222:223], v4 offset:16128
  v_mfma_f32_32x32x16_bf16 v[192:207], v[228:231], v[100:103], v[192:207]
  buffer_load_dwordx4 a[0:3], v246, s[56:59], s81 offen offset:0 sc1
  ds_read_b64_tr_b16 v[224:225], v4 offset:18432
  ds_read_b64_tr_b16 v[226:227], v4 offset:19200
  buffer_load_dword a237, v25, s[56:59], s89 offen sc1
  s_add_u32 s89, s89, 65536
  s_waitcnt lgkmcnt(6)
  v_mfma_f32_32x32x16_bf16 v[160:175], v[208:211], v[104:107], v[160:175]
  ds_read_b64_tr_b16 v[228:229], v4 offset:21504
  ds_read_b64_tr_b16 v[230:231], v4 offset:22272
  v_mfma_f32_32x32x16_bf16 v[160:175], v[212:215], v[108:111], v[160:175]
  ds_read_b64_tr_b16 v[208:209], v4 offset:24576
  ds_read_b64_tr_b16 v[210:211], v4 offset:25344
  buffer_load_dword a238, v25, s[56:59], s89 offen sc1
  s_add_u32 s89, s89, 65536
  s_waitcnt lgkmcnt(6)
  v_mfma_f32_32x32x16_bf16 v[160:175], v[216:219], v[112:115], v[160:175]
  ds_read_b64_tr_b16 v[212:213], v4 offset:27648
  ds_read_b64_tr_b16 v[214:215], v4 offset:28416
  buffer_load_dwordx4 a[4:7], v18, s[56:59], s81 offen offset:0 sc1
  v_mfma_f32_32x32x16_bf16 v[160:175], v[220:223], v[116:119], v[160:175]
  ds_read_b64_tr_b16 v[216:217], v4 offset:30720
  ds_read_b64_tr_b16 v[218:219], v4 offset:31488
  buffer_load_dword a239, v25, s[56:59], s89 offen sc1
  s_waitcnt lgkmcnt(6)
  v_mfma_f32_32x32x16_bf16 v[160:175], v[224:227], v[120:123], v[160:175]
  ds_read_b64_tr_b16 v[220:221], v4 offset:33792
  ds_read_b64_tr_b16 v[222:223], v4 offset:34560
  v_mfma_f32_32x32x16_bf16 v[160:175], v[228:231], v[124:127], v[160:175]
  ds_read_b64_tr_b16 v[224:225], v4 offset:36864
  ds_read_b64_tr_b16 v[226:227], v4 offset:37632
  s_waitcnt lgkmcnt(6)
  v_mfma_f32_32x32x16_bf16 v[160:175], v[208:211], v[128:131], v[160:175]
  ds_read_b64_tr_b16 v[228:229], v4 offset:39936
  ds_read_b64_tr_b16 v[230:231], v4 offset:40704
  buffer_load_dwordx4 a[8:11], v246, s[56:59], s81 offen offset:2048 sc1
  v_mfma_f32_32x32x16_bf16 v[160:175], v[212:215], v[132:135], v[160:175]
  ds_read_b64_tr_b16 v[208:209], v4 offset:43008
  ds_read_b64_tr_b16 v[210:211], v4 offset:43776
  s_waitcnt lgkmcnt(6)
  v_mfma_f32_32x32x16_bf16 v[160:175], v[216:219], v[136:139], v[160:175]
  ds_read_b64_tr_b16 v[212:213], v4 offset:46080
  ds_read_b64_tr_b16 v[214:215], v4 offset:46848
  v_mfma_f32_32x32x16_bf16 v[160:175], v[220:223], v[140:143], v[160:175]
  ds_read_b64_tr_b16 v[216:217], v4 offset:6208
  ds_read_b64_tr_b16 v[218:219], v4 offset:6976
  buffer_load_dwordx4 a[12:15], v18, s[56:59], s81 offen offset:2048 sc1
  s_add_u32 s81, s81, 4096
  s_waitcnt lgkmcnt(6)
  v_mfma_f32_32x32x16_bf16 v[160:175], v[224:227], v[144:147], v[160:175]
  ds_read_b64_tr_b16 v[220:221], v4 offset:9280
  ds_read_b64_tr_b16 v[222:223], v4 offset:10048
  v_mfma_f32_32x32x16_bf16 v[160:175], v[228:231], v[148:151], v[160:175]
  ds_read_b64_tr_b16 v[224:225], v4 offset:12352
  ds_read_b64_tr_b16 v[226:227], v4 offset:13120
  s_waitcnt lgkmcnt(6)
  s_waitcnt vmcnt(13)
  v_mfma_f32_32x32x16_bf16 v[160:175], v[208:211], v[152:155], v[160:175]
  ds_read_b64_tr_b16 v[228:229], v4 offset:15424
  ds_read_b64_tr_b16 v[230:231], v4 offset:16192
  s_waitcnt vmcnt(12)
  v_mfma_f32_32x32x16_bf16 v[160:175], v[212:215], v[156:159], v[160:175]
  ds_read_b64_tr_b16 v[208:209], v4 offset:18496
  ds_read_b64_tr_b16 v[210:211], v4 offset:19264
  buffer_load_dwordx4 a[16:19], v246, s[56:59], s81 offen offset:0 sc1
  s_waitcnt lgkmcnt(6)
  v_mfma_f32_32x32x16_bf16 v[176:191], v[216:219], v[104:107], v[176:191]
  ds_read_b64_tr_b16 v[212:213], v4 offset:21568
  ds_read_b64_tr_b16 v[214:215], v4 offset:22336
  v_mfma_f32_32x32x16_bf16 v[176:191], v[220:223], v[108:111], v[176:191]
  ds_read_b64_tr_b16 v[216:217], v4 offset:24640
  ds_read_b64_tr_b16 v[218:219], v4 offset:25408
  s_waitcnt lgkmcnt(6)
  v_mfma_f32_32x32x16_bf16 v[176:191], v[224:227], v[112:115], v[176:191]
  ds_read_b64_tr_b16 v[220:221], v4 offset:27712
  ds_read_b64_tr_b16 v[222:223], v4 offset:28480
  buffer_load_dwordx4 a[20:23], v18, s[56:59], s81 offen offset:0 sc1
  v_mfma_f32_32x32x16_bf16 v[176:191], v[228:231], v[116:119], v[176:191]
  v_max_f32 v160, 0, v160
  ds_read_b64_tr_b16 v[224:225], v4 offset:30784
  ds_read_b64_tr_b16 v[226:227], v4 offset:31552
  v_max_f32 v161, 0, v161
  v_max_f32 v162, 0, v162
  s_waitcnt lgkmcnt(6)
  v_mfma_f32_32x32x16_bf16 v[176:191], v[208:211], v[120:123], v[176:191]
  ds_read_b64_tr_b16 v[228:229], v4 offset:33856
  ds_read_b64_tr_b16 v[230:231], v4 offset:34624
  v_max_f32 v163, 0, v163
  v_max_f32 v164, 0, v164
  v_max_f32 v165, 0, v165
  v_mfma_f32_32x32x16_bf16 v[176:191], v[212:215], v[124:127], v[176:191]
  ds_read_b64_tr_b16 v[208:209], v4 offset:36928
  ds_read_b64_tr_b16 v[210:211], v4 offset:37696
  v_max_f32 v166, 0, v166
  v_max_f32 v167, 0, v167
  s_waitcnt lgkmcnt(6)
  v_mfma_f32_32x32x16_bf16 v[176:191], v[216:219], v[128:131], v[176:191]
  v_pk_mul_f32 v[160:161], v[160:161], v[160:161]
  ds_read_b64_tr_b16 v[212:213], v4 offset:40000
  ds_read_b64_tr_b16 v[214:215], v4 offset:40768
  v_pk_mul_f32 v[162:163], v[162:163], v[162:163]
  buffer_load_dwordx4 a[24:27], v246, s[56:59], s81 offen offset:2048 sc1
  v_pk_mul_f32 v[164:165], v[164:165], v[164:165]
  v_mfma_f32_32x32x16_bf16 v[176:191], v[220:223], v[132:135], v[176:191]
  ds_read_b64_tr_b16 v[216:217], v4 offset:43072
  ds_read_b64_tr_b16 v[218:219], v4 offset:43840
  v_pk_mul_f32 v[166:167], v[166:167], v[166:167]
  v_cvt_pk_bf16_f32 v160, v160, v161
  v_cvt_pk_bf16_f32 v161, v162, v163
  s_waitcnt lgkmcnt(6)
  v_mfma_f32_32x32x16_bf16 v[176:191], v[224:227], v[136:139], v[176:191]
  ds_read_b64_tr_b16 v[220:221], v4 offset:46144
  ds_read_b64_tr_b16 v[222:223], v4 offset:46912
  v_cvt_pk_bf16_f32 v162, v164, v165
  v_cvt_pk_bf16_f32 v163, v166, v167
  v_mfma_f32_32x32x16_bf16 v[176:191], v[228:231], v[140:143], v[176:191]
  v_max_f32 v168, 0, v168
  ds_read_b64_tr_b16 v[224:225], v4 offset:6272
  ds_read_b64_tr_b16 v[226:227], v4 offset:7040
  v_max_f32 v169, 0, v169
  v_max_f32 v170, 0, v170
  s_waitcnt lgkmcnt(6)
  v_mfma_f32_32x32x16_bf16 v[176:191], v[208:211], v[144:147], v[176:191]
  buffer_store_dwordx4 v[160:163], v2, s[56:59], s84 offen offset:0 sc1
  buffer_load_dwordx4 a[28:31], v18, s[56:59], s81 offen offset:2048 sc1
  s_add_u32 s81, s81, 4096
  ds_read_b64_tr_b16 v[228:229], v4 offset:9344
  ds_read_b64_tr_b16 v[230:231], v4 offset:10112
  v_max_f32 v171, 0, v171
  v_max_f32 v172, 0, v172
  v_max_f32 v173, 0, v173
  v_mfma_f32_32x32x16_bf16 v[176:191], v[212:215], v[148:151], v[176:191]
  ds_read_b64_tr_b16 v[208:209], v4 offset:12416
  ds_read_b64_tr_b16 v[210:211], v4 offset:13184
  v_max_f32 v174, 0, v174
  v_max_f32 v175, 0, v175
  s_waitcnt lgkmcnt(6)
  v_mfma_f32_32x32x16_bf16 v[176:191], v[216:219], v[152:155], v[176:191]
  v_pk_mul_f32 v[168:169], v[168:169], v[168:169]
  ds_read_b64_tr_b16 v[212:213], v4 offset:15488
  ds_read_b64_tr_b16 v[214:215], v4 offset:16256
  v_pk_mul_f32 v[170:171], v[170:171], v[170:171]
  v_pk_mul_f32 v[172:173], v[172:173], v[172:173]
  v_mfma_f32_32x32x16_bf16 v[176:191], v[220:223], v[156:159], v[176:191]
  ds_read_b128 v[32:35], v12 offset:16896
  ds_read_b64_tr_b16 v[216:217], v4 offset:18560
  ds_read_b64_tr_b16 v[218:219], v4 offset:19328
  v_pk_mul_f32 v[174:175], v[174:175], v[174:175]
  v_cvt_pk_bf16_f32 v168, v168, v169
  buffer_load_dwordx4 a[32:35], v246, s[56:59], s81 offen offset:0 sc1
  v_cvt_pk_bf16_f32 v169, v170, v171
  s_waitcnt lgkmcnt(7)
  v_mfma_f32_32x32x16_bf16 v[192:207], v[224:227], v[104:107], v[192:207]
  ds_read_b128 v[40:43], v13 offset:0
  ds_read_b64_tr_b16 v[220:221], v4 offset:21632
  ds_read_b64_tr_b16 v[222:223], v4 offset:22400
  v_cvt_pk_bf16_f32 v170, v172, v173
  v_cvt_pk_bf16_f32 v171, v174, v175
  v_mfma_f32_32x32x16_bf16 v[192:207], v[228:231], v[108:111], v[192:207]
  ds_read_b128 v[36:39], v12 offset:25344
  ds_read_b64_tr_b16 v[224:225], v4 offset:24704
  ds_read_b64_tr_b16 v[226:227], v4 offset:25472
  s_waitcnt lgkmcnt(9)
  v_mfma_f32_32x32x16_bf16 v[192:207], v[208:211], v[112:115], v[192:207]
  ds_read_b128 v[44:47], v12 offset:16960
  ds_read_b64_tr_b16 v[228:229], v4 offset:27776
  ds_read_b64_tr_b16 v[230:231], v4 offset:28544
  v_mfma_f32_32x32x16_bf16 v[192:207], v[212:215], v[116:119], v[192:207]
  ds_read_b128 v[52:55], v13 offset:64
  v_max_f32 v176, 0, v176
  buffer_store_dwordx4 v[168:171], v2, s[56:59], s84 offen offset:1024 sc1
  ds_read_b64_tr_b16 v[208:209], v4 offset:30848
  ds_read_b64_tr_b16 v[210:211], v4 offset:31616
  buffer_load_dwordx4 a[36:39], v18, s[56:59], s81 offen offset:0 sc1
  v_max_f32 v177, 0, v177
  v_max_f32 v178, 0, v178
  s_waitcnt lgkmcnt(9)
  v_mfma_f32_32x32x16_bf16 v[192:207], v[216:219], v[120:123], v[192:207]
  ds_read_b128 v[48:51], v12 offset:25408
  v_max_f32 v179, 0, v179
  ds_read_b64_tr_b16 v[212:213], v4 offset:33920
  ds_read_b64_tr_b16 v[214:215], v4 offset:34688
  v_max_f32 v180, 0, v180
  v_max_f32 v181, 0, v181
  v_mfma_f32_32x32x16_bf16 v[192:207], v[220:223], v[124:127], v[192:207]
  ds_read_b128 v[56:59], v12 offset:17024
  v_max_f32 v182, 0, v182
  ds_read_b64_tr_b16 v[216:217], v4 offset:36992
  ds_read_b64_tr_b16 v[218:219], v4 offset:37760
  v_max_f32 v183, 0, v183
  v_pk_mul_f32 v[176:177], v[176:177], v[176:177]
  s_waitcnt lgkmcnt(9)
  v_mfma_f32_32x32x16_bf16 v[192:207], v[224:227], v[128:131], v[192:207]
  ds_read_b128 v[64:67], v13 offset:128
  v_pk_mul_f32 v[178:179], v[178:179], v[178:179]
  ds_read_b64_tr_b16 v[220:221], v4 offset:40064
  ds_read_b64_tr_b16 v[222:223], v4 offset:40832
  v_pk_mul_f32 v[180:181], v[180:181], v[180:181]
  v_pk_mul_f32 v[182:183], v[182:183], v[182:183]
  buffer_load_dwordx4 a[40:43], v246, s[56:59], s81 offen offset:2048 sc1
  v_mfma_f32_32x32x16_bf16 v[192:207], v[228:231], v[132:135], v[192:207]
  ds_read_b128 v[60:63], v12 offset:25472
  ds_read_b64_tr_b16 v[224:225], v4 offset:43136
  ds_read_b64_tr_b16 v[226:227], v4 offset:43904
  v_cvt_pk_bf16_f32 v176, v176, v177
  v_cvt_pk_bf16_f32 v177, v178, v179
  v_cvt_pk_bf16_f32 v178, v180, v181
  s_waitcnt lgkmcnt(9)
  v_mfma_f32_32x32x16_bf16 v[192:207], v[208:211], v[136:139], v[192:207]
  ds_read_b128 v[68:71], v12 offset:17088
  ds_read_b64_tr_b16 v[228:229], v4 offset:46208
  ds_read_b64_tr_b16 v[230:231], v4 offset:46976
  v_cvt_pk_bf16_f32 v179, v182, v183
  v_max_f32 v184, 0, v184
  v_max_f32 v185, 0, v185
  v_mfma_f32_32x32x16_bf16 v[192:207], v[212:215], v[140:143], v[192:207]
  ds_read_b128 v[76:79], v13 offset:192
  v_max_f32 v186, 0, v186
  v_max_f32 v187, 0, v187
  v_max_f32 v188, 0, v188
  s_waitcnt lgkmcnt(7)
  v_mfma_f32_32x32x16_bf16 v[192:207], v[216:219], v[144:147], v[192:207]
  ds_read_b128 v[72:75], v12 offset:25536
  v_max_f32 v189, 0, v189
  buffer_load_dwordx4 a[44:47], v18, s[56:59], s81 offen offset:2048 sc1
  s_add_u32 s81, s81, 4096
  v_max_f32 v190, 0, v190
  v_max_f32 v191, 0, v191
  v_mfma_f32_32x32x16_bf16 v[192:207], v[220:223], v[148:151], v[192:207]
  ds_read_b128 v[80:83], v12 offset:17152
  buffer_store_dwordx4 v[176:179], v2, s[56:59], s22 offen offset:0 sc1
  v_pk_mul_f32 v[184:185], v[184:185], v[184:185]
  v_pk_mul_f32 v[186:187], v[186:187], v[186:187]
  v_pk_mul_f32 v[188:189], v[188:189], v[188:189]
  s_waitcnt lgkmcnt(3)
  v_mfma_f32_32x32x16_bf16 v[192:207], v[224:227], v[152:155], v[192:207]
  ds_read_b128 v[88:91], v13 offset:256
  v_pk_mul_f32 v[190:191], v[190:191], v[190:191]
  v_cvt_pk_bf16_f32 v184, v184, v185
  v_cvt_pk_bf16_f32 v185, v186, v187
  v_mfma_f32_32x32x16_bf16 v[192:207], v[228:231], v[156:159], v[192:207]
  ds_read_b128 v[84:87], v12 offset:25600
  v_cvt_pk_bf16_f32 v186, v188, v189
  v_cvt_pk_bf16_f32 v187, v190, v191
  s_nop 8
  v_max_f32 v192, 0, v192
  v_max_f32 v193, 0, v193
  v_max_f32 v194, 0, v194
  ds_read_b128 v[92:95], v12 offset:17216
  v_max_f32 v195, 0, v195
  ds_read_b128 v[100:103], v13 offset:320
  v_max_f32 v196, 0, v196
  buffer_load_dwordx4 a[48:51], v246, s[56:59], s81 offen offset:0 sc1
  ds_read_b128 v[96:99], v12 offset:25664
  v_max_f32 v197, 0, v197
  v_mfma_f32_16x16x32_bf16 v[208:211], v[32:35], v[40:43], 0
  v_max_f32 v198, 0, v198
  v_mfma_f32_16x16x32_bf16 v[212:215], v[36:39], v[40:43], 0
  v_max_f32 v199, 0, v199
  ds_read_b128 v[104:107], v12 offset:17280
  v_pk_mul_f32 v[192:193], v[192:193], v[192:193]
  ds_read_b128 v[112:115], v13 offset:384
  v_pk_mul_f32 v[194:195], v[194:195], v[194:195]
  ds_read_b128 v[108:111], v12 offset:25728
  v_pk_mul_f32 v[196:197], v[196:197], v[196:197]
  buffer_load_dwordx4 a[52:55], v18, s[56:59], s81 offen offset:0 sc1
  v_mfma_f32_16x16x32_bf16 v[208:211], v[44:47], v[52:55], v[208:211]
  v_pk_mul_f32 v[198:199], v[198:199], v[198:199]
  v_cvt_pk_bf16_f32 v192, v192, v193
  v_mfma_f32_16x16x32_bf16 v[212:215], v[48:51], v[52:55], v[212:215]
  v_cvt_pk_bf16_f32 v193, v194, v195
  ds_read_b128 v[116:119], v12 offset:17344
  v_cvt_pk_bf16_f32 v194, v196, v197
  ds_read_b128 v[124:127], v13 offset:448
  v_cvt_pk_bf16_f32 v195, v198, v199
  ds_read_b128 v[120:123], v12 offset:25792
  v_max_f32 v200, 0, v200
  v_mfma_f32_16x16x32_bf16 v[208:211], v[56:59], v[64:67], v[208:211]
  v_max_f32 v201, 0, v201
  buffer_load_dwordx4 a[56:59], v246, s[56:59], s81 offen offset:2048 sc1
  v_mfma_f32_16x16x32_bf16 v[212:215], v[60:63], v[64:67], v[212:215]
  v_max_f32 v202, 0, v202
  s_waitcnt lgkmcnt(13)
  v_mfma_f32_16x16x32_bf16 v[208:211], v[68:71], v[76:79], v[208:211]
  v_max_f32 v203, 0, v203
  s_waitcnt lgkmcnt(12)
  v_mfma_f32_16x16x32_bf16 v[212:215], v[72:75], v[76:79], v[212:215]
  v_max_f32 v204, 0, v204
  buffer_store_dwordx4 v[184:187], v2, s[56:59], s22 offen offset:1024 sc1
  v_max_f32 v205, 0, v205
  s_waitcnt lgkmcnt(10)
  v_mfma_f32_16x16x32_bf16 v[208:211], v[80:83], v[88:91], v[208:211]
  v_max_f32 v206, 0, v206
  s_waitcnt lgkmcnt(9)
  v_mfma_f32_16x16x32_bf16 v[212:215], v[84:87], v[88:91], v[212:215]
  v_max_f32 v207, 0, v207
  s_waitcnt lgkmcnt(7)
  v_mfma_f32_16x16x32_bf16 v[208:211], v[92:95], v[100:103], v[208:211]
  buffer_load_dwordx4 a[60:63], v18, s[56:59], s81 offen offset:2048 sc1
  s_add_u32 s81, s81, 4096
  v_pk_mul_f32 v[200:201], v[200:201], v[200:201]
  s_waitcnt lgkmcnt(6)
  v_mfma_f32_16x16x32_bf16 v[212:215], v[96:99], v[100:103], v[212:215]
  v_pk_mul_f32 v[202:203], v[202:203], v[202:203]
  s_waitcnt lgkmcnt(4)
  v_mfma_f32_16x16x32_bf16 v[208:211], v[104:107], v[112:115], v[208:211]
  v_pk_mul_f32 v[204:205], v[204:205], v[204:205]
  s_waitcnt lgkmcnt(3)
  v_mfma_f32_16x16x32_bf16 v[212:215], v[108:111], v[112:115], v[212:215]
  v_pk_mul_f32 v[206:207], v[206:207], v[206:207]
  s_waitcnt lgkmcnt(1)
  v_mfma_f32_16x16x32_bf16 v[208:211], v[116:119], v[124:127], v[208:211]
  v_cvt_pk_bf16_f32 v200, v200, v201
  s_waitcnt lgkmcnt(0)
  v_mfma_f32_16x16x32_bf16 v[212:215], v[120:123], v[124:127], v[212:215]
  v_cvt_pk_bf16_f32 v201, v202, v203
  v_cvt_pk_bf16_f32 v202, v204, v205
  v_cvt_pk_bf16_f32 v203, v206, v207
  v_mov_b32 v216, s79
  ds_write_b32 v216, v6 offset:2048
  v_add_f32 v208, v208, v17
  v_cvt_pk_bf16_f32 v210, v210, v211
  v_cvt_pk_bf16_f32 v208, v208, v209
  v_cvt_pk_bf16_f32 v212, v212, v213
  v_cvt_pk_bf16_f32 v214, v214, v215
  ds_write_b32 v14, v208
  ds_write_b32 v15, v210
  ds_write_b16 v16, v212
  ds_write_b16_d16_hi v16, v212 offset:64
  ds_write_b16 v16, v214 offset:128
  ds_write_b16_d16_hi v16, v214 offset:192
  buffer_store_dwordx4 v[192:195], v2, s[56:59], s23 offen offset:0 sc1
  s_waitcnt lgkmcnt(0)
  s_barrier
  ds_read_u16 v128, v232 offset:0
  ds_read_u16 v129, v233 offset:0
  ds_read_u16 v130, v233 offset:2
  buffer_load_dwordx4 a[64:67], v246, s[56:59], s81 offen offset:0 sc1
  ds_read_u16 v131, v234 offset:0
  ds_read_u16 v132, v235 offset:0
  ds_read_u16 v133, v236 offset:0
  ds_read_u16 v134, v237 offset:0
  ds_read_u16 v135, v238 offset:0
  ds_read_u16 v136, v239 offset:0
  ds_read_u16 v137, v237 offset:128
  ds_read_u16 v138, v238 offset:128
  ds_read_u16 v139, v239 offset:128
  buffer_load_dwordx4 a[68:71], v18, s[56:59], s81 offen offset:0 sc1
  ds_read_u16 v140, v240 offset:0
  ds_read_u16 v141, v241 offset:0
  ds_read_u16 v142, v242 offset:0
  ds_read_u16 v143, v240 offset:64
  ds_read_u16 v144, v241 offset:64
  ds_read_u16 v145, v242 offset:64
  ds_read_u16 v146, v240 offset:128
  ds_read_u16 v147, v241 offset:128
  ds_read_u16 v148, v242 offset:128
  ds_read_u16 v149, v240 offset:192
  buffer_load_dwordx4 a[72:75], v246, s[56:59], s81 offen offset:2048 sc1
  ds_read_u16 v150, v241 offset:192
  ds_read_u16 v151, v242 offset:192
  s_waitcnt vmcnt(31)
  ds_write_b16 v26, a232 offset:896
  ds_write_b16_d16_hi v26, a232 offset:5504
  s_waitcnt vmcnt(30)
  ds_write_b16 v26, a233 offset:768
  ds_write_b16_d16_hi v26, a233 offset:5376
  s_waitcnt vmcnt(29)
  ds_write_b16 v26, a234 offset:640
  ds_write_b16_d16_hi v26, a234 offset:5248
  s_waitcnt vmcnt(28)
  ds_write_b16 v26, a235 offset:512
  ds_write_b16_d16_hi v26, a235 offset:5120
  buffer_load_dwordx4 a[76:79], v18, s[56:59], s81 offen offset:2048 sc1
  s_add_u32 s81, s81, 4096
  s_waitcnt vmcnt(28)
  ds_write_b16 v26, a236 offset:384
  ds_write_b16_d16_hi v26, a236 offset:4992
  s_waitcnt vmcnt(26)
  ds_write_b16 v26, a237 offset:256
  ds_write_b16_d16_hi v26, a237 offset:4864
  s_waitcnt vmcnt(25)
  ds_write_b16 v26, a238 offset:128
  buffer_store_dwordx4 v[200:203], v2, s[56:59], s23 offen offset:1024 sc1
  ds_write_b16_d16_hi v26, a238 offset:4736
  s_waitcnt vmcnt(24)
  ds_write_b16 v26, a239 offset:0
  ds_write_b16_d16_hi v26, a239 offset:4608
  ds_write_b64 v251, v[30:31] offset:20736
  buffer_load_dwordx4 v[204:207], v245, s[52:55], s91 offen offset:0
  buffer_load_dwordx4 a[80:83], v246, s[56:59], s81 offen offset:0 sc1
  ds_write_b64 v251, v[30:31] offset:20744
  v_cmp_gt_u32 vcc, 7, v27
  s_and_saveexec_b64 s[14:15], vcc
  ds_write_addtid_b32 v6
  ds_write_addtid_b32 v6 offset:4160
  s_mov_b64 exec, s[14:15]
  s_waitcnt lgkmcnt(15)
  v_lshl_or_b32 v128, v129, 16, v128
  v_lshl_or_b32 v129, v130, 16, v129
  ds_write_addtid_b32 v128 offset:28
  ds_write_addtid_b32 v129 offset:4188
  v_lshl_or_b32 v131, v132, 16, v131
  v_lshl_or_b32 v132, v133, 16, v132
  ds_write_addtid_b32 v131 offset:540
  ds_write_addtid_b32 v132 offset:4700
  buffer_load_dwordx4 a[84:87], v18, s[56:59], s81 offen offset:0 sc1
  v_lshl_or_b32 v134, v135, 16, v134
  v_lshl_or_b32 v135, v136, 16, v135
  ds_write_addtid_b32 v134 offset:1052
  ds_write_addtid_b32 v135 offset:5212
  v_lshl_or_b32 v137, v138, 16, v137
  buffer_load_dwordx4 v[196:199], v245, s[52:55], s91 offen offset:32
  v_lshl_or_b32 v138, v139, 16, v138
  ds_write_addtid_b32 v137 offset:1564
  ds_write_addtid_b32 v138 offset:5724
  v_lshl_or_b32 v140, v141, 16, v140
  v_lshl_or_b32 v141, v142, 16, v141
  buffer_load_dwordx4 a[88:91], v246, s[56:59], s81 offen offset:2048 sc1
  ds_write_addtid_b32 v140 offset:2076
  ds_write_addtid_b32 v141 offset:6236
  v_lshl_or_b32 v143, v144, 16, v143
  v_lshl_or_b32 v144, v145, 16, v144
  ds_write_addtid_b32 v143 offset:2588
  ds_write_addtid_b32 v144 offset:6748
  v_lshl_or_b32 v146, v147, 16, v146
  v_lshl_or_b32 v147, v148, 16, v147
  ds_write_addtid_b32 v146 offset:3100
  ds_write_addtid_b32 v147 offset:7260
  v_lshl_or_b32 v149, v150, 16, v149
  v_lshl_or_b32 v150, v151, 16, v150
  ds_write_addtid_b32 v149 offset:3612
  ds_write_addtid_b32 v150 offset:7772
  s_waitcnt lgkmcnt(0)
  s_barrier
  ds_read2_b32 v[32:33], v10 offset0:0 offset1:1
  ds_read2_b32 v[34:35], v10 offset0:2 offset1:3
  ds_read_b128 v[64:67], v11 offset:3584
  ds_read_b128 v[68:71], v11 offset:3072
  ds_read_b128 v[72:75], v11 offset:2560
  ds_read_b128 v[76:79], v11 offset:2048
  ds_read_b128 v[80:83], v11 offset:1536
  ds_read_b128 v[84:87], v11 offset:1024
  ds_read_b128 v[88:91], v11 offset:512
  ds_read_b128 v[92:95], v11 offset:0
  ds_read2_b32 v[36:37], v10 offset0:128 offset1:129
  ds_read2_b32 v[38:39], v10 offset0:130 offset1:131
  .p2alignl 3, 0xbf800000
  s_waitcnt lgkmcnt(9)
  v_mfma_f32_16x16x32_bf16 v[208:211], v[32:35], v[64:67], 0
  ds_read2_b32 v[40:41], v7 offset0:0 offset1:1
  ds_read2_b32 v[42:43], v7 offset0:2 offset1:3
  s_waitcnt lgkmcnt(10)
  v_mfma_f32_16x16x32_bf16 v[212:215], v[32:35], v[68:71], 0
  buffer_load_dwordx4 a[92:95], v18, s[56:59], s81 offen offset:2048 sc1
  s_add_u32 s81, s81, 4096
  ds_read2_b32 v[44:45], v7 offset0:128 offset1:129
  s_waitcnt lgkmcnt(10)
  v_mfma_f32_16x16x32_bf16 v[216:219], v[32:35], v[72:75], 0
  ds_read2_b32 v[46:47], v7 offset0:130 offset1:131
  v_subrev_u32 v240, 16384, v247
  v_xor_b32 v241, 0x1000, v240
  ds_read2_b32 v[48:49], v8 offset0:0 offset1:1
  s_waitcnt lgkmcnt(11)
  v_mfma_f32_16x16x32_bf16 v[220:223], v[32:35], v[76:79], 0
  ds_read2_b32 v[50:51], v8 offset0:2 offset1:3
  s_waitcnt lgkmcnt(11)
  v_mfma_f32_16x16x32_bf16 v[224:227], v[32:35], v[80:83], 0
  ds_read2_b32 v[52:53], v8 offset0:128 offset1:129
  s_waitcnt vmcnt(6)
  s_mov_b64 exec, 1
  buffer_store_dword v5, v6, s[56:59], s86 offen sc1
  s_mov_b64 exec, -1
  ds_read2_b32 v[54:55], v8 offset0:130 offset1:131
  s_waitcnt lgkmcnt(12)
  v_mfma_f32_16x16x32_bf16 v[228:231], v[32:35], v[84:87], 0
  ds_read2_b32 v[56:57], v9 offset0:0 offset1:1
  buffer_load_dwordx4 a[96:99], v246, s[56:59], s81 offen offset:0 sc1
  s_waitcnt lgkmcnt(12)
  v_mfma_f32_16x16x32_bf16 v[232:235], v[32:35], v[88:91], 0
  ds_read2_b32 v[58:59], v9 offset0:2 offset1:3
  ds_read2_b32 v[60:61], v9 offset0:128 offset1:129
  s_waitcnt lgkmcnt(13)
  v_mfma_f32_16x16x32_bf16 v[236:239], v[32:35], v[92:95], 0
  ds_read2_b32 v[62:63], v9 offset0:130 offset1:131
  s_waitcnt lgkmcnt(12)
  v_mfma_f32_16x16x32_bf16 v[212:215], v[36:39], v[64:67], v[212:215]
  ds_read_b128 v[128:131], v11 offset:3648
  v_mfma_f32_16x16x32_bf16 v[216:219], v[36:39], v[68:71], v[216:219]
  ds_read_b128 v[132:135], v11 offset:3136
  buffer_load_dwordx4 a[100:103], v18, s[56:59], s81 offen offset:0 sc1
  v_mfma_f32_16x16x32_bf16 v[220:223], v[36:39], v[72:75], v[220:223]
  ds_read_b128 v[136:139], v11 offset:2624
  v_mfma_f32_16x16x32_bf16 v[224:227], v[36:39], v[76:79], v[224:227]
  ds_read_b128 v[140:143], v11 offset:2112
  v_mfma_f32_16x16x32_bf16 v[228:231], v[36:39], v[80:83], v[228:231]
  ds_read_b128 v[144:147], v11 offset:1600
  v_mfma_f32_16x16x32_bf16 v[232:235], v[36:39], v[84:87], v[232:235]
  ds_read_b128 v[148:151], v11 offset:1088
  v_mfma_f32_16x16x32_bf16 v[236:239], v[36:39], v[88:91], v[236:239]
  buffer_load_dwordx4 a[104:107], v246, s[56:59], s81 offen offset:2048 sc1
  ds_read_b128 v[152:155], v11 offset:576
  s_waitcnt lgkmcnt(15)
  v_mfma_f32_16x16x32_bf16 v[216:219], v[40:43], v[64:67], v[216:219]
  ds_read_b128 v[156:159], v11 offset:64
  v_mfma_f32_16x16x32_bf16 v[220:223], v[40:43], v[68:71], v[220:223]
  ds_read2_b32 v[96:97], v10 offset0:16 offset1:17
  v_mfma_f32_16x16x32_bf16 v[224:227], v[40:43], v[72:75], v[224:227]
  ds_read2_b32 v[98:99], v10 offset0:18 offset1:19
  v_mfma_f32_16x16x32_bf16 v[228:231], v[40:43], v[76:79], v[228:231]
  buffer_load_dwordx4 a[108:111], v18, s[56:59], s81 offen offset:2048 sc1
  s_add_u32 s81, s81, 4096
  ds_read2_b32 v[100:101], v10 offset0:144 offset1:145
  v_mfma_f32_16x16x32_bf16 v[232:235], v[40:43], v[80:83], v[232:235]
  ds_read2_b32 v[102:103], v10 offset0:146 offset1:147
  v_mfma_f32_16x16x32_bf16 v[236:239], v[40:43], v[84:87], v[236:239]
  v_mfma_f32_16x16x32_bf16 v[220:223], v[44:47], v[64:67], v[220:223]
  ds_read2_b32 v[104:105], v7 offset0:16 offset1:17
  v_mfma_f32_16x16x32_bf16 v[224:227], v[44:47], v[68:71], v[224:227]
  ds_read2_b32 v[106:107], v7 offset0:18 offset1:19
  buffer_load_dwordx4 a[112:115], v246, s[56:59], s81 offen offset:0 sc1
  v_mfma_f32_16x16x32_bf16 v[228:231], v[44:47], v[72:75], v[228:231]
  ds_read2_b32 v[108:109], v7 offset0:144 offset1:145
  v_mfma_f32_16x16x32_bf16 v[232:235], v[44:47], v[76:79], v[232:235]
  ds_read2_b32 v[110:111], v7 offset0:146 offset1:147
  v_mfma_f32_16x16x32_bf16 v[236:239], v[44:47], v[80:83], v[236:239]
  ds_read2_b32 v[112:113], v8 offset0:16 offset1:17
  s_waitcnt lgkmcnt(15)
  v_mfma_f32_16x16x32_bf16 v[224:227], v[48:51], v[64:67], v[224:227]
  ds_read2_b32 v[114:115], v8 offset0:18 offset1:19
  v_mfma_f32_16x16x32_bf16 v[228:231], v[48:51], v[68:71], v[228:231]
  buffer_load_dwordx4 a[116:119], v18, s[56:59], s81 offen offset:0 sc1
  ds_read2_b32 v[116:117], v8 offset0:144 offset1:145
  v_mfma_f32_16x16x32_bf16 v[232:235], v[48:51], v[72:75], v[232:235]
  ds_read2_b32 v[118:119], v8 offset0:146 offset1:147
  v_mfma_f32_16x16x32_bf16 v[236:239], v[48:51], v[76:79], v[236:239]
  ds_read2_b32 v[120:121], v9 offset0:16 offset1:17
  v_mfma_f32_16x16x32_bf16 v[228:231], v[52:55], v[64:67], v[228:231]
  ds_read2_b32 v[122:123], v9 offset0:18 offset1:19
  v_mfma_f32_16x16x32_bf16 v[232:235], v[52:55], v[68:71], v[232:235]
  buffer_load_dwordx4 a[120:123], v246, s[56:59], s81 offen offset:2048 sc1
  ds_read2_b32 v[124:125], v9 offset0:144 offset1:145
  v_mfma_f32_16x16x32_bf16 v[236:239], v[52:55], v[72:75], v[236:239]
  ds_read2_b32 v[126:127], v9 offset0:146 offset1:147
  v_mfma_f32_16x16x32_bf16 v[232:235], v[56:59], v[64:67], v[232:235]
  v_mfma_f32_16x16x32_bf16 v[236:239], v[56:59], v[68:71], v[236:239]
  v_mfma_f32_16x16x32_bf16 v[236:239], v[60:63], v[64:67], v[236:239]
  buffer_load_dwordx4 a[124:127], v18, s[56:59], s81 offen offset:2048 sc1
  s_add_u32 s81, s81, 4096
  s_waitcnt lgkmcnt(14)
  v_mfma_f32_16x16x32_bf16 v[208:211], v[96:99], v[128:131], v[208:211]
  ds_read_b128 v[64:67], v11 offset:3712
  v_mfma_f32_16x16x32_bf16 v[212:215], v[96:99], v[132:135], v[212:215]
  ds_read_b128 v[68:71], v11 offset:3200
  v_mfma_f32_16x16x32_bf16 v[216:219], v[96:99], v[136:139], v[216:219]
  ds_read_b128 v[72:75], v11 offset:2688
  v_mfma_f32_16x16x32_bf16 v[220:223], v[96:99], v[140:143], v[220:223]
  v_mfma_f32_16x16x32_bf16 v[224:227], v[96:99], v[144:147], v[224:227]
  buffer_load_dwordx4 a[128:131], v246, s[56:59], s81 offen offset:0 sc1
  ds_read_b128 v[76:79], v11 offset:2176
  v_mfma_f32_16x16x32_bf16 v[228:231], v[96:99], v[148:151], v[228:231]
  ds_read_b128 v[80:83], v11 offset:1664
  v_mfma_f32_16x16x32_bf16 v[232:235], v[96:99], v[152:155], v[232:235]
  v_mfma_f32_16x16x32_bf16 v[236:239], v[96:99], v[156:159], v[236:239]
  ds_read_b128 v[84:87], v11 offset:1152
  s_waitcnt lgkmcnt(15)
  v_mfma_f32_16x16x32_bf16 v[212:215], v[100:103], v[128:131], v[212:215]
  buffer_load_dwordx4 a[132:135], v18, s[56:59], s81 offen offset:0 sc1
  ds_read_b128 v[88:91], v11 offset:640
  v_mfma_f32_16x16x32_bf16 v[216:219], v[100:103], v[132:135], v[216:219]
  ds_read_b128 v[92:95], v11 offset:128
  v_mfma_f32_16x16x32_bf16 v[220:223], v[100:103], v[136:139], v[220:223]
  v_mfma_f32_16x16x32_bf16 v[224:227], v[100:103], v[140:143], v[224:227]
  ds_read2_b32 v[32:33], v10 offset0:32 offset1:33
  v_mfma_f32_16x16x32_bf16 v[228:231], v[100:103], v[144:147], v[228:231]
  buffer_load_dwordx4 a[136:139], v246, s[56:59], s81 offen offset:2048 sc1
  ds_read2_b32 v[34:35], v10 offset0:34 offset1:35
  v_mfma_f32_16x16x32_bf16 v[232:235], v[100:103], v[148:151], v[232:235]
  v_mfma_f32_16x16x32_bf16 v[236:239], v[100:103], v[152:155], v[236:239]
  ds_read2_b32 v[36:37], v10 offset0:160 offset1:161
  v_mfma_f32_16x16x32_bf16 v[216:219], v[104:107], v[128:131], v[216:219]
  ds_read2_b32 v[38:39], v10 offset0:162 offset1:163
  v_mfma_f32_16x16x32_bf16 v[220:223], v[104:107], v[132:135], v[220:223]
  v_mfma_f32_16x16x32_bf16 v[224:227], v[104:107], v[136:139], v[224:227]
  ds_read2_b32 v[40:41], v7 offset0:32 offset1:33
  buffer_load_dwordx4 a[140:143], v18, s[56:59], s81 offen offset:2048 sc1
  s_add_u32 s81, s81, 4096
  v_mfma_f32_16x16x32_bf16 v[228:231], v[104:107], v[140:143], v[228:231]
  ds_read2_b32 v[42:43], v7 offset0:34 offset1:35
  v_mfma_f32_16x16x32_bf16 v[232:235], v[104:107], v[144:147], v[232:235]
  ds_read2_b32 v[44:45], v7 offset0:160 offset1:161
  v_mfma_f32_16x16x32_bf16 v[236:239], v[104:107], v[148:151], v[236:239]
  s_waitcnt lgkmcnt(15)
  v_mfma_f32_16x16x32_bf16 v[220:223], v[108:111], v[128:131], v[220:223]
  ds_read2_b32 v[46:47], v7 offset0:162 offset1:163
  buffer_load_dwordx4 a[144:147], v246, s[56:59], s81 offen offset:0 sc1
  v_mfma_f32_16x16x32_bf16 v[224:227], v[108:111], v[132:135], v[224:227]
  ds_read2_b32 v[48:49], v8 offset0:32 offset1:33
  v_mfma_f32_16x16x32_bf16 v[228:231], v[108:111], v[136:139], v[228:231]
  v_mfma_f32_16x16x32_bf16 v[232:235], v[108:111], v[140:143], v[232:235]
  ds_read2_b32 v[50:51], v8 offset0:34 offset1:35
  v_mfma_f32_16x16x32_bf16 v[236:239], v[108:111], v[144:147], v[236:239]
  ds_read2_b32 v[52:53], v8 offset0:160 offset1:161
  buffer_load_dwordx4 a[148:151], v18, s[56:59], s81 offen offset:0 sc1
  v_mfma_f32_16x16x32_bf16 v[224:227], v[112:115], v[128:131], v[224:227]
  buffer_load_dword v23, v21, s[56:59], 0 offen sc1
  ds_read2_b32 v[54:55], v8 offset0:162 offset1:163
  v_mfma_f32_16x16x32_bf16 v[228:231], v[112:115], v[132:135], v[228:231]
  v_mfma_f32_16x16x32_bf16 v[232:235], v[112:115], v[136:139], v[232:235]
  ds_read2_b32 v[56:57], v9 offset0:32 offset1:33
  v_mfma_f32_16x16x32_bf16 v[236:239], v[112:115], v[140:143], v[236:239]
  ds_read2_b32 v[58:59], v9 offset0:34 offset1:35
  v_mfma_f32_16x16x32_bf16 v[228:231], v[116:119], v[128:131], v[228:231]
  buffer_load_dwordx4 a[152:155], v246, s[56:59], s81 offen offset:2048 sc1
  v_mfma_f32_16x16x32_bf16 v[232:235], v[116:119], v[132:135], v[232:235]
  ds_read2_b32 v[60:61], v9 offset0:160 offset1:161
  v_mfma_f32_16x16x32_bf16 v[236:239], v[116:119], v[136:139], v[236:239]
  ds_read2_b32 v[62:63], v9 offset0:162 offset1:163
  v_mfma_f32_16x16x32_bf16 v[232:235], v[120:123], v[128:131], v[232:235]
  v_mfma_f32_16x16x32_bf16 v[236:239], v[120:123], v[132:135], v[236:239]
  buffer_load_dwordx4 a[156:159], v18, s[56:59], s81 offen offset:2048 sc1
  s_add_u32 s81, s81, 4096
  v_mfma_f32_16x16x32_bf16 v[236:239], v[124:127], v[128:131], v[236:239]
  s_waitcnt lgkmcnt(14)
  v_mfma_f32_16x16x32_bf16 v[208:211], v[32:35], v[64:67], v[208:211]
  ds_read_b128 v[128:131], v11 offset:3776
  v_mfma_f32_16x16x32_bf16 v[212:215], v[32:35], v[68:71], v[212:215]
  ds_read_b128 v[132:135], v11 offset:3264
  v_mfma_f32_16x16x32_bf16 v[216:219], v[32:35], v[72:75], v[216:219]
  buffer_load_dwordx4 a[160:163], v246, s[56:59], s81 offen offset:0 sc1
  ds_read_b128 v[136:139], v11 offset:2752
  v_mfma_f32_16x16x32_bf16 v[220:223], v[32:35], v[76:79], v[220:223]
  v_mfma_f32_16x16x32_bf16 v[224:227], v[32:35], v[80:83], v[224:227]
  ds_read_b128 v[140:143], v11 offset:2240
  v_mfma_f32_16x16x32_bf16 v[228:231], v[32:35], v[84:87], v[228:231]
  ds_read_b128 v[144:147], v11 offset:1728
  v_mfma_f32_16x16x32_bf16 v[232:235], v[32:35], v[88:91], v[232:235]
  v_mfma_f32_16x16x32_bf16 v[236:239], v[32:35], v[92:95], v[236:239]
  buffer_load_dwordx4 a[164:167], v18, s[56:59], s81 offen offset:0 sc1
  ds_read_b128 v[148:151], v11 offset:1216
  s_waitcnt lgkmcnt(15)
  v_mfma_f32_16x16x32_bf16 v[212:215], v[36:39], v[64:67], v[212:215]
  ds_read_b128 v[152:155], v11 offset:704
  v_mfma_f32_16x16x32_bf16 v[216:219], v[36:39], v[68:71], v[216:219]
  ds_read_b128 v[156:159], v11 offset:192
  v_mfma_f32_16x16x32_bf16 v[220:223], v[36:39], v[72:75], v[220:223]
  v_mfma_f32_16x16x32_bf16 v[224:227], v[36:39], v[76:79], v[224:227]
  ds_read2_b32 v[96:97], v10 offset0:48 offset1:49
  buffer_load_dwordx4 a[168:171], v246, s[56:59], s81 offen offset:2048 sc1
  v_mfma_f32_16x16x32_bf16 v[228:231], v[36:39], v[80:83], v[228:231]
  ds_read2_b32 v[98:99], v10 offset0:50 offset1:51
  v_mfma_f32_16x16x32_bf16 v[232:235], v[36:39], v[84:87], v[232:235]
  v_mfma_f32_16x16x32_bf16 v[236:239], v[36:39], v[88:91], v[236:239]
  ds_read2_b32 v[100:101], v10 offset0:176 offset1:177
  v_mfma_f32_16x16x32_bf16 v[216:219], v[40:43], v[64:67], v[216:219]
  ds_read2_b32 v[102:103], v10 offset0:178 offset1:179
  buffer_load_dwordx4 a[172:175], v18, s[56:59], s81 offen offset:2048 sc1
  s_add_u32 s81, s81, 4096
  v_mfma_f32_16x16x32_bf16 v[220:223], v[40:43], v[68:71], v[220:223]
  v_mfma_f32_16x16x32_bf16 v[224:227], v[40:43], v[72:75], v[224:227]
  ds_read2_b32 v[104:105], v7 offset0:48 offset1:49
  v_mfma_f32_16x16x32_bf16 v[228:231], v[40:43], v[76:79], v[228:231]
  ds_read2_b32 v[106:107], v7 offset0:50 offset1:51
  v_mfma_f32_16x16x32_bf16 v[232:235], v[40:43], v[80:83], v[232:235]
  ds_read2_b32 v[108:109], v7 offset0:176 offset1:177
  v_mfma_f32_16x16x32_bf16 v[236:239], v[40:43], v[84:87], v[236:239]
  s_waitcnt lgkmcnt(15)
  v_mfma_f32_16x16x32_bf16 v[220:223], v[44:47], v[64:67], v[220:223]
  ds_read2_b32 v[110:111], v7 offset0:178 offset1:179
  v_mfma_f32_16x16x32_bf16 v[224:227], v[44:47], v[68:71], v[224:227]
  ds_read2_b32 v[112:113], v8 offset0:48 offset1:49
  v_mfma_f32_16x16x32_bf16 v[228:231], v[44:47], v[72:75], v[228:231]
  v_mfma_f32_16x16x32_bf16 v[232:235], v[44:47], v[76:79], v[232:235]
  s_waitcnt vmcnt(6)
  v_cmp_ne_u32 vcc, s11, v23
  s_cbranch_vccnz L_spin3
L_back3:
  ds_read2_b32 v[114:115], v8 offset0:50 offset1:51
  v_mfma_f32_16x16x32_bf16 v[236:239], v[44:47], v[80:83], v[236:239]
  buffer_load_dwordx4 a[176:179], v2, s[56:59], s82 offen offset:0 sc1
  ds_read2_b32 v[116:117], v8 offset0:176 offset1:177
  v_mfma_f32_16x16x32_bf16 v[224:227], v[48:51], v[64:67], v[224:227]
  ds_read2_b32 v[118:119], v8 offset0:178 offset1:179
  v_mfma_f32_16x16x32_bf16 v[228:231], v[48:51], v[68:71], v[228:231]
  v_mfma_f32_16x16x32_bf16 v[232:235], v[48:51], v[72:75], v[232:235]
  ds_read2_b32 v[120:121], v9 offset0:48 offset1:49
  buffer_load_dwordx4 a[180:183], v2, s[56:59], s83 offen offset:0 sc1
  v_mfma_f32_16x16x32_bf16 v[236:239], v[48:51], v[76:79], v[236:239]
  ds_read2_b32 v[122:123], v9 offset0:50 offset1:51
  v_mfma_f32_16x16x32_bf16 v[228:231], v[52:55], v[64:67], v[228:231]
  v_mfma_f32_16x16x32_bf16 v[232:235], v[52:55], v[68:71], v[232:235]
  ds_read2_b32 v[124:125], v9 offset0:176 offset1:177
  v_mfma_f32_16x16x32_bf16 v[236:239], v[52:55], v[72:75], v[236:239]
  ds_read2_b32 v[126:127], v9 offset0:178 offset1:179
  buffer_load_dwordx4 a[184:187], v2, s[56:59], s82 offen offset:1024 sc1
  v_mfma_f32_16x16x32_bf16 v[232:235], v[56:59], v[64:67], v[232:235]
  v_mfma_f32_16x16x32_bf16 v[236:239], v[56:59], v[68:71], v[236:239]
  v_mfma_f32_16x16x32_bf16 v[236:239], v[60:63], v[64:67], v[236:239]
  s_waitcnt lgkmcnt(14)
  v_mfma_f32_16x16x32_bf16 v[208:211], v[96:99], v[128:131], v[208:211]
  buffer_load_dwordx4 a[188:191], v2, s[56:59], s83 offen offset:1024 sc1
  v_mfma_f32_16x16x32_bf16 v[212:215], v[96:99], v[132:135], v[212:215]
  v_mfma_f32_16x16x32_bf16 v[216:219], v[96:99], v[136:139], v[216:219]
  v_mfma_f32_16x16x32_bf16 v[220:223], v[96:99], v[140:143], v[220:223]
  v_mfma_f32_16x16x32_bf16 v[224:227], v[96:99], v[144:147], v[224:227]
  buffer_load_dwordx4 a[192:195], v2, s[56:59], s82 offen offset:2048 sc1
  v_mfma_f32_16x16x32_bf16 v[228:231], v[96:99], v[148:151], v[228:231]
  v_mfma_f32_16x16x32_bf16 v[232:235], v[96:99], v[152:155], v[232:235]
  v_mfma_f32_16x16x32_bf16 v[236:239], v[96:99], v[156:159], v[236:239]
  s_waitcnt lgkmcnt(12)
  v_mfma_f32_16x16x32_bf16 v[212:215], v[100:103], v[128:131], v[212:215]
  buffer_load_dwordx4 a[196:199], v2, s[56:59], s83 offen offset:2048 sc1
  v_mfma_f32_16x16x32_bf16 v[216:219], v[100:103], v[132:135], v[216:219]
  v_mfma_f32_16x16x32_bf16 v[220:223], v[100:103], v[136:139], v[220:223]
  v_mfma_f32_16x16x32_bf16 v[224:227], v[100:103], v[140:143], v[224:227]
  v_mfma_f32_16x16x32_bf16 v[228:231], v[100:103], v[144:147], v[228:231]
  buffer_load_dwordx4 a[200:203], v2, s[56:59], s82 offen offset:3072 sc1
  s_add_u32 s82, s82, 4096
  v_mfma_f32_16x16x32_bf16 v[232:235], v[100:103], v[148:151], v[232:235]
  v_mfma_f32_16x16x32_bf16 v[236:239], v[100:103], v[152:155], v[236:239]
  s_waitcnt lgkmcnt(10)
  v_mfma_f32_16x16x32_bf16 v[216:219], v[104:107], v[128:131], v[216:219]
  v_mfma_f32_16x16x32_bf16 v[220:223], v[104:107], v[132:135], v[220:223]
  buffer_load_dwordx4 a[204:207], v2, s[56:59], s83 offen offset:3072 sc1
  s_add_u32 s83, s83, 4096
  v_mfma_f32_16x16x32_bf16 v[224:227], v[104:107], v[136:139], v[224:227]
  v_mfma_f32_16x16x32_bf16 v[228:231], v[104:107], v[140:143], v[228:231]
  v_mfma_f32_16x16x32_bf16 v[232:235], v[104:107], v[144:147], v[232:235]
  v_mfma_f32_16x16x32_bf16 v[236:239], v[104:107], v[148:151], v[236:239]
  buffer_load_dwordx4 a[208:211], v2, s[56:59], s82 offen offset:0 sc1
  s_waitcnt lgkmcnt(8)
  v_mfma_f32_16x16x32_bf16 v[220:223], v[108:111], v[128:131], v[220:223]
  v_mfma_f32_16x16x32_bf16 v[224:227], v[108:111], v[132:135], v[224:227]
  v_mfma_f32_16x16x32_bf16 v[228:231], v[108:111], v[136:139], v[228:231]
  v_mfma_f32_16x16x32_bf16 v[232:235], v[108:111], v[140:143], v[232:235]
  buffer_load_dwordx4 a[212:215], v2, s[56:59], s83 offen offset:0 sc1
  v_mfma_f32_16x16x32_bf16 v[236:239], v[108:111], v[144:147], v[236:239]
  s_waitcnt lgkmcnt(6)
  v_mfma_f32_16x16x32_bf16 v[224:227], v[112:115], v[128:131], v[224:227]
  v_mfma_f32_16x16x32_bf16 v[228:231], v[112:115], v[132:135], v[228:231]
  v_mfma_f32_16x16x32_bf16 v[232:235], v[112:115], v[136:139], v[232:235]
  buffer_load_dwordx4 a[216:219], v2, s[56:59], s82 offen offset:1024 sc1
  v_mfma_f32_16x16x32_bf16 v[236:239], v[112:115], v[140:143], v[236:239]
  s_waitcnt lgkmcnt(4)
  v_mfma_f32_16x16x32_bf16 v[228:231], v[116:119], v[128:131], v[228:231]
  v_mfma_f32_16x16x32_bf16 v[232:235], v[116:119], v[132:135], v[232:235]
  v_mfma_f32_16x16x32_bf16 v[236:239], v[116:119], v[136:139], v[236:239]
  buffer_load_dwordx4 a[220:223], v2, s[56:59], s83 offen offset:1024 sc1
  s_waitcnt lgkmcnt(2)
  v_mfma_f32_16x16x32_bf16 v[232:235], v[120:123], v[128:131], v[232:235]
  v_mfma_f32_16x16x32_bf16 v[236:239], v[120:123], v[132:135], v[236:239]
  s_waitcnt lgkmcnt(0)
  v_mfma_f32_16x16x32_bf16 v[236:239], v[124:127], v[128:131], v[236:239]
  s_cmp_eq_u32 s50, 0
  s_cbranch_scc0 L_cx1
  ds_write_b128 v240, v[224:227] offset:0
  ds_write_b128 v240, v[228:231] offset:1024
  s_nop 0
  ds_write_b128 v240, v[232:235] offset:2048
  s_nop 1
  ds_write_b128 v240, v[236:239] offset:3072
  s_branch L_cx2
L_cx1:
  ds_write_b128 v240, v[208:211] offset:0
  ds_write_b128 v240, v[212:215] offset:1024
  ds_write_b128 v240, v[216:219] offset:2048
  ds_write_b128 v240, v[220:223] offset:3072
  v_pk_mov_b32 v[208:209], v[224:225], v[224:225] op_sel:[0,1]
  v_pk_mov_b32 v[210:211], v[226:227], v[226:227] op_sel:[0,1]
  v_pk_mov_b32 v[212:213], v[228:229], v[228:229] op_sel:[0,1]
  v_pk_mov_b32 v[214:215], v[230:231], v[230:231] op_sel:[0,1]
  v_pk_mov_b32 v[216:217], v[232:233], v[232:233] op_sel:[0,1]
  v_pk_mov_b32 v[218:219], v[234:235], v[234:235] op_sel:[0,1]
  v_pk_mov_b32 v[220:221], v[236:237], v[236:237] op_sel:[0,1]
  v_pk_mov_b32 v[222:223], v[238:239], v[238:239] op_sel:[0,1]
L_cx2:
  buffer_load_dwordx4 a[224:227], v2, s[56:59], s82 offen offset:2048 sc1
  buffer_load_dwordx4 a[228:231], v2, s[56:59], s83 offen offset:2048 sc1
  buffer_load_dwordx4 a[232:235], v2, s[56:59], s82 offen offset:3072 sc1
  s_add_u32 s82, s82, 4096
  s_waitcnt lgkmcnt(0)
  s_barrier
  ds_read_b128 v[224:227], v241 offset:0
  ds_read_b128 v[228:231], v241 offset:1024
  ds_read_b128 v[232:235], v241 offset:2048
  ds_read_b128 v[236:239], v241 offset:3072
  buffer_load_dwordx4 a[236:239], v2, s[56:59], s83 offen offset:3072 sc1
  s_add_u32 s83, s83, 4096
  buffer_load_dwordx4 v[160:163], v2, s[56:59], s82 offen offset:0 sc1
  buffer_load_dwordx4 v[164:167], v2, s[56:59], s83 offen offset:0 sc1
  s_waitcnt lgkmcnt(3)
  v_pk_add_f32 v[224:225], v[224:225], v[208:209]
  v_pk_add_f32 v[226:227], v[226:227], v[210:211]
  s_waitcnt lgkmcnt(2)
  v_pk_add_f32 v[228:229], v[228:229], v[212:213]
  v_pk_add_f32 v[230:231], v[230:231], v[214:215]
  s_waitcnt lgkmcnt(1)
  v_pk_add_f32 v[232:233], v[232:233], v[216:217]
  v_pk_add_f32 v[234:235], v[234:235], v[218:219]
  s_waitcnt lgkmcnt(0)
  v_pk_add_f32 v[236:237], v[236:237], v[220:221]
  v_pk_add_f32 v[238:239], v[238:239], v[222:223]
  v_cvt_pk_bf16_f32 v224, v224, v225
  v_cvt_pk_bf16_f32 v225, v226, v227
  v_cvt_pk_bf16_f32 v226, v228, v229
  v_cvt_pk_bf16_f32 v227, v230, v231
  v_cvt_pk_bf16_f32 v228, v232, v233
  v_cvt_pk_bf16_f32 v229, v234, v235
  v_cvt_pk_bf16_f32 v230, v236, v237
  v_cvt_pk_bf16_f32 v231, v238, v239
  buffer_store_dwordx2 v[224:225], v244, s[56:59], s88 offen offset:0 sc1
  buffer_store_dwordx2 v[226:227], v244, s[56:59], s88 offen offset:512 sc1
  buffer_store_dwordx2 v[228:229], v244, s[56:59], s88 offen offset:1024 sc1
  buffer_store_dwordx2 v[230:231], v244, s[56:59], s88 offen offset:1536 sc1
  .p2alignl 3, 0xbf800000
  v_mfma_f32_32x32x16_bf16 v[32:47], a[252:255], v[28:31], 0
  buffer_load_dwordx4 v[168:171], v2, s[56:59], s82 offen offset:1024 sc1
  s_waitcnt vmcnt(22)
  v_mfma_f32_32x32x16_bf16 v[32:47], a[0:3], a[176:179], v[32:47]
  v_mfma_f32_32x32x16_bf16 v[48:63], a[4:7], a[176:179], 0
  buffer_load_dwordx4 v[172:175], v2, s[56:59], s83 offen offset:1024 sc1
  s_waitcnt vmcnt(22)
  v_mfma_f32_32x32x16_bf16 v[64:79], a[0:3], a[180:183], 0
  v_mfma_f32_32x32x16_bf16 v[80:95], a[4:7], a[180:183], 0
  v_xor_b32 v240, 0x1000, v247
  v_xor_b32 v241, 0x2000, v247
  v_xor_b32 v242, 0x3000, v247
  s_mov_b32 s14, 0xbfb8aa3b
  buffer_load_dwordx4 v[176:179], v2, s[56:59], s82 offen offset:2048 sc1
  s_waitcnt vmcnt(22)
  v_mfma_f32_32x32x16_bf16 v[32:47], a[8:11], a[184:187], v[32:47]
  v_mfma_f32_32x32x16_bf16 v[48:63], a[12:15], a[184:187], v[48:63]
  buffer_load_dwordx4 v[180:183], v2, s[56:59], s83 offen offset:2048 sc1
  s_waitcnt vmcnt(22)
  v_mfma_f32_32x32x16_bf16 v[64:79], a[8:11], a[188:191], v[64:79]
  v_mfma_f32_32x32x16_bf16 v[80:95], a[12:15], a[188:191], v[80:95]
  buffer_load_dwordx4 v[184:187], v2, s[56:59], s82 offen offset:3072 sc1
  s_add_u32 s82, s82, 4096
  s_waitcnt vmcnt(22)
  v_mfma_f32_32x32x16_bf16 v[32:47], a[16:19], a[192:195], v[32:47]
  v_mfma_f32_32x32x16_bf16 v[48:63], a[20:23], a[192:195], v[48:63]
  buffer_load_dwordx4 v[188:191], v2, s[56:59], s83 offen offset:3072 sc1
  s_add_u32 s83, s83, 4096
  s_waitcnt vmcnt(22)
  v_mfma_f32_32x32x16_bf16 v[64:79], a[16:19], a[196:199], v[64:79]
  v_mfma_f32_32x32x16_bf16 v[80:95], a[20:23], a[196:199], v[80:95]
  buffer_load_dwordx4 a[240:243], v2, s[56:59], s82 offen offset:0 sc1
  s_waitcnt vmcnt(22)
  v_mfma_f32_32x32x16_bf16 v[32:47], a[24:27], a[200:203], v[32:47]
  v_mfma_f32_32x32x16_bf16 v[48:63], a[28:31], a[200:203], v[48:63]
  buffer_load_dwordx4 a[244:247], v2, s[56:59], s83 offen offset:0 sc1
  s_waitcnt vmcnt(22)
  v_mfma_f32_32x32x16_bf16 v[64:79], a[24:27], a[204:207], v[64:79]
  v_mfma_f32_32x32x16_bf16 v[80:95], a[28:31], a[204:207], v[80:95]
  s_waitcnt vmcnt(8)
  s_mov_b64 exec, 1
  buffer_store_dword v5, v6, s[56:59], s87 offen sc1
  s_mov_b64 exec, -1
  buffer_load_dwordx4 v[192:195], v2, s[56:59], s82 offen offset:1024 sc1
  v_mfma_f32_32x32x16_bf16 v[32:47], a[32:35], a[208:211], v[32:47]
  v_mfma_f32_32x32x16_bf16 v[48:63], a[36:39], a[208:211], v[48:63]
  buffer_load_dwordx4 v[200:203], v2, s[56:59], s83 offen offset:1024 sc1
  v_mfma_f32_32x32x16_bf16 v[64:79], a[32:35], a[212:215], v[64:79]
  v_mfma_f32_32x32x16_bf16 v[80:95], a[36:39], a[212:215], v[80:95]
  buffer_load_dwordx4 v[96:99], v2, s[56:59], s82 offen offset:2048 sc1
  v_mfma_f32_32x32x16_bf16 v[32:47], a[40:43], a[216:219], v[32:47]
  v_mfma_f32_32x32x16_bf16 v[48:63], a[44:47], a[216:219], v[48:63]
  buffer_load_dwordx4 v[100:103], v2, s[56:59], s83 offen offset:2048 sc1
  v_mfma_f32_32x32x16_bf16 v[64:79], a[40:43], a[220:223], v[64:79]
  v_mfma_f32_32x32x16_bf16 v[80:95], a[44:47], a[220:223], v[80:95]
  buffer_load_dwordx4 v[104:107], v2, s[56:59], s82 offen offset:3072 sc1
  s_add_u32 s82, s82, 4096
  v_mfma_f32_32x32x16_bf16 v[32:47], a[48:51], a[224:227], v[32:47]
  v_mfma_f32_32x32x16_bf16 v[48:63], a[52:55], a[224:227], v[48:63]
  v_permlane32_swap_b32 v204, v206
  buffer_load_dwordx4 v[108:111], v2, s[56:59], s83 offen offset:3072 sc1
  s_add_u32 s83, s83, 4096
  v_permlane32_swap_b32 v205, v207
  v_mfma_f32_32x32x16_bf16 v[64:79], a[48:51], a[228:231], v[64:79]
  v_permlane32_swap_b32 v196, v198
  v_mfma_f32_32x32x16_bf16 v[80:95], a[52:55], a[228:231], v[80:95]
  buffer_load_dwordx4 v[112:115], v2, s[56:59], s82 offen offset:0 sc1
  v_permlane32_swap_b32 v197, v199
  v_mfma_f32_32x32x16_bf16 v[32:47], a[56:59], a[232:235], v[32:47]
  v_lshlrev_b32 v208, 16, v204
  v_mfma_f32_32x32x16_bf16 v[48:63], a[60:63], a[232:235], v[48:63]
  buffer_load_dwordx4 v[116:119], v2, s[56:59], s83 offen offset:0 sc1
  v_and_b32 v209, 0xffff0000, v204
  v_mfma_f32_32x32x16_bf16 v[64:79], a[56:59], a[236:239], v[64:79]
  v_lshlrev_b32 v210, 16, v205
  v_mfma_f32_32x32x16_bf16 v[80:95], a[60:63], a[236:239], v[80:95]
  v_and_b32 v211, 0xffff0000, v205
  buffer_load_dwordx4 v[120:123], v2, s[56:59], s82 offen offset:1024 sc1
  v_mfma_f32_32x32x16_bf16 v[32:47], a[64:67], v[160:163], v[32:47]
  v_lshlrev_b32 v212, 16, v206
  v_mfma_f32_32x32x16_bf16 v[48:63], a[68:71], v[160:163], v[48:63]
  v_and_b32 v213, 0xffff0000, v206
  buffer_load_dwordx4 v[124:127], v2, s[56:59], s83 offen offset:1024 sc1
  v_mfma_f32_32x32x16_bf16 v[64:79], a[64:67], v[164:167], v[64:79]
  v_lshlrev_b32 v214, 16, v207
  v_and_b32 v215, 0xffff0000, v207
  v_mfma_f32_32x32x16_bf16 v[80:95], a[68:71], v[164:167], v[80:95]
  buffer_load_dwordx4 v[128:131], v2, s[56:59], s82 offen offset:2048 sc1
  v_lshlrev_b32 v216, 16, v196
  s_waitcnt vmcnt(19)
  v_mfma_f32_32x32x16_bf16 v[32:47], a[72:75], v[168:171], v[32:47]
  v_and_b32 v217, 0xffff0000, v196
  v_mfma_f32_32x32x16_bf16 v[48:63], a[76:79], v[168:171], v[48:63]
  buffer_load_dwordx4 v[132:135], v2, s[56:59], s83 offen offset:2048 sc1
  v_lshlrev_b32 v218, 16, v197
  s_waitcnt vmcnt(19)
  v_mfma_f32_32x32x16_bf16 v[64:79], a[72:75], v[172:175], v[64:79]
  v_and_b32 v219, 0xffff0000, v197
  v_mfma_f32_32x32x16_bf16 v[80:95], a[76:79], v[172:175], v[80:95]
  v_lshlrev_b32 v220, 16, v198
  buffer_load_dwordx4 v[136:139], v2, s[56:59], s82 offen offset:3072 sc1
  s_add_u32 s82, s82, 4096
  s_waitcnt vmcnt(19)
  v_mfma_f32_32x32x16_bf16 v[32:47], a[80:83], v[176:179], v[32:47]
  v_and_b32 v221, 0xffff0000, v198
  v_mfma_f32_32x32x16_bf16 v[48:63], a[84:87], v[176:179], v[48:63]
  v_lshlrev_b32 v222, 16, v199
  buffer_load_dwordx4 v[140:143], v2, s[56:59], s83 offen offset:3072 sc1
  s_add_u32 s83, s83, 4096
  s_waitcnt vmcnt(19)
  v_mfma_f32_32x32x16_bf16 v[64:79], a[80:83], v[180:183], v[64:79]
  v_and_b32 v223, 0xffff0000, v199
  v_mfma_f32_32x32x16_bf16 v[80:95], a[84:87], v[180:183], v[80:95]
  s_cmp_eq_u32 s3, 3
  s_cselect_b32 s12, 4096, 0
  s_sub_u32 s82, s82, s12
  buffer_load_dwordx4 v[144:147], v2, s[56:59], s82 offen offset:0 sc1
  s_waitcnt vmcnt(19)
  v_mfma_f32_32x32x16_bf16 v[32:47], a[88:91], v[184:187], v[32:47]
  v_mfma_f32_32x32x16_bf16 v[48:63], a[92:95], v[184:187], v[48:63]
  s_mul_i32 s36, s51, 4608
  s_cmp_eq_u32 s3, 3
  s_cselect_b32 s12, 4096, 0
  s_sub_u32 s83, s83, s12
  buffer_load_dwordx4 v[148:151], v2, s[56:59], s83 offen offset:0 sc1
  s_lshl_b32 s37, s50, 6
  s_waitcnt vmcnt(19)
  v_mfma_f32_32x32x16_bf16 v[64:79], a[88:91], v[188:191], v[64:79]
  s_add_u32 s36, s36, s37
  s_add_u32 s36, s36, 110592
  v_mfma_f32_32x32x16_bf16 v[80:95], a[92:95], v[188:191], v[80:95]
  v_and_b32 v244, 31, v1
  buffer_load_dwordx4 v[152:155], v2, s[56:59], s82 offen offset:1024 sc1
  s_waitcnt vmcnt(19)
  v_mfma_f32_32x32x16_bf16 v[32:47], a[96:99], a[240:243], v[32:47]
  v_mul_u32_u24 v244, 144, v244
  v_lshrrev_b32 v246, 5, v1
  v_mfma_f32_32x32x16_bf16 v[48:63], a[100:103], a[240:243], v[48:63]
  v_lshl_add_u32 v244, v246, 4, v244
  buffer_load_dwordx4 v[156:159], v2, s[56:59], s83 offen offset:1024 sc1
  v_add_u32 v244, s36, v244
  s_waitcnt vmcnt(19)
  v_mfma_f32_32x32x16_bf16 v[64:79], a[96:99], a[244:247], v[64:79]
  s_mul_i32 s36, s3, 2304
  v_mfma_f32_32x32x16_bf16 v[80:95], a[100:103], a[244:247], v[80:95]
  s_add_u32 s36, s36, 110592
  v_lshrrev_b32 v251, 3, v1
  s_waitcnt vmcnt(17)
  v_mfma_f32_32x32x16_bf16 v[32:47], a[104:107], v[192:195], v[32:47]
  v_mul_u32_u24 v246, 144, v251
  v_and_b32 v0, 7, v1
  v_mfma_f32_32x32x16_bf16 v[48:63], a[108:111], v[192:195], v[48:63]
  v_lshl_add_u32 v246, v0, 4, v246
  s_waitcnt vmcnt(16)
  v_mfma_f32_32x32x16_bf16 v[64:79], a[104:107], v[200:203], v[64:79]
  v_add_u32 v246, s36, v246
  v_lshlrev_b32 v251, 10, v251
  v_mfma_f32_32x32x16_bf16 v[80:95], a[108:111], v[200:203], v[80:95]
  v_lshl_add_u32 v251, v0, 4, v251
  s_lshl2_add_u32 s36, s9, s3
  s_waitcnt vmcnt(15)
  v_mfma_f32_32x32x16_bf16 v[32:47], a[112:115], v[96:99], v[32:47]
  s_lshl_b32 s36, s36, 14
  v_mfma_f32_32x32x16_bf16 v[48:63], a[116:119], v[96:99], v[48:63]
  s_lshl_b32 s37, s10, 7
  s_add_u32 s36, s36, s37
  s_waitcnt vmcnt(14)
  v_mfma_f32_32x32x16_bf16 v[64:79], a[112:115], v[100:103], v[64:79]
  s_add_u32 s37, s36, 8192
  v_mfma_f32_32x32x16_bf16 v[80:95], a[116:119], v[100:103], v[80:95]
  buffer_load_dword v23, v22, s[56:59], 0 offen sc1
  s_waitcnt vmcnt(14)
  v_mfma_f32_32x32x16_bf16 v[32:47], a[120:123], v[104:107], v[32:47]
  v_mfma_f32_32x32x16_bf16 v[48:63], a[124:127], v[104:107], v[48:63]
  s_waitcnt vmcnt(13)
  v_mfma_f32_32x32x16_bf16 v[64:79], a[120:123], v[108:111], v[64:79]
  v_mfma_f32_32x32x16_bf16 v[80:95], a[124:127], v[108:111], v[80:95]
  s_waitcnt vmcnt(12)
  v_mfma_f32_32x32x16_bf16 v[48:63], a[132:135], v[112:115], v[48:63]
  s_waitcnt vmcnt(10)
  v_mfma_f32_32x32x16_bf16 v[48:63], a[140:143], v[120:123], v[48:63]
  s_waitcnt vmcnt(8)
  v_mfma_f32_32x32x16_bf16 v[48:63], a[148:151], v[128:131], v[48:63]
  s_waitcnt vmcnt(6)
  v_mfma_f32_32x32x16_bf16 v[48:63], a[156:159], v[136:139], v[48:63]
  s_waitcnt vmcnt(4)
  v_mfma_f32_32x32x16_bf16 v[48:63], a[164:167], v[144:147], v[48:63]
  s_waitcnt vmcnt(2)
  v_mfma_f32_32x32x16_bf16 v[48:63], a[172:175], v[152:155], v[48:63]
  v_mfma_f32_32x32x16_bf16 v[64:79], a[128:131], v[116:119], v[64:79]
  v_mfma_f32_32x32x16_bf16 v[64:79], a[136:139], v[124:127], v[64:79]
  s_nop 9
  ds_write_b128 v240, v[48:51] offset:0
  v_mfma_f32_32x32x16_bf16 v[64:79], a[144:147], v[132:135], v[64:79]
  ds_write_b128 v240, v[52:55] offset:1024
  v_mfma_f32_32x32x16_bf16 v[64:79], a[152:155], v[140:143], v[64:79]
  s_waitcnt vmcnt(0)
  v_cmp_ne_u32 vcc, s11, v23
  s_cbranch_vccnz L_spin4
L_back4:
  buffer_load_dwordx4 v[232:235], v248, s[56:59], s90 offen sc1
  buffer_load_dwordx4 v[236:239], v248, s[56:59], s25 offen sc1
  v_mfma_f32_32x32x16_bf16 v[64:79], a[160:163], v[148:151], v[64:79]
  ds_write_b128 v240, v[56:59] offset:2048
  v_mfma_f32_32x32x16_bf16 v[64:79], a[168:171], v[156:159], v[64:79]
  ds_write_b128 v240, v[60:63] offset:3072
  v_mfma_f32_32x32x16_bf16 v[80:95], a[132:135], v[116:119], v[80:95]
  v_mfma_f32_32x32x16_bf16 v[80:95], a[140:143], v[124:127], v[80:95]
  s_nop 8
  ds_write_b128 v241, v[64:67] offset:16384
  v_mfma_f32_32x32x16_bf16 v[80:95], a[148:151], v[132:135], v[80:95]
  ds_write_b128 v241, v[68:71] offset:17408
  v_mfma_f32_32x32x16_bf16 v[80:95], a[156:159], v[140:143], v[80:95]
  v_mfma_f32_32x32x16_bf16 v[80:95], a[164:167], v[148:151], v[80:95]
  ds_write_b128 v241, v[72:75] offset:18432
  v_mfma_f32_32x32x16_bf16 v[80:95], a[172:175], v[156:159], v[80:95]
  ds_write_b128 v241, v[76:79] offset:19456
  v_mfma_f32_32x32x16_bf16 v[32:47], a[128:131], v[112:115], v[32:47]
  v_mfma_f32_32x32x16_bf16 v[32:47], a[136:139], v[120:123], v[32:47]
  s_nop 8
  ds_write_b128 v242, v[80:83] offset:32768
  ds_write_b128 v242, v[84:87] offset:33792
  v_mfma_f32_32x32x16_bf16 v[32:47], a[144:147], v[128:131], v[32:47]
  ds_write_b128 v242, v[88:91] offset:34816
  ds_write_b128 v242, v[92:95] offset:35840
  v_mfma_f32_32x32x16_bf16 v[32:47], a[152:155], v[136:139], v[32:47]
  s_waitcnt lgkmcnt(0)
  s_barrier
  ds_read_b128 v[160:163], v247 offset:0
  ds_read_b128 v[176:179], v247 offset:16384
  ds_read_b128 v[192:195], v247 offset:32768
  v_mfma_f32_32x32x16_bf16 v[32:47], a[160:163], v[144:147], v[32:47]
  ds_read_b128 v[164:167], v247 offset:1024
  ds_read_b128 v[180:183], v247 offset:17408
  ds_read_b128 v[196:199], v247 offset:33792
  ds_read_b128 v[168:171], v247 offset:2048
  ds_read_b128 v[184:187], v247 offset:18432
  ds_read_b128 v[200:203], v247 offset:34816
  v_mfma_f32_32x32x16_bf16 v[32:47], a[168:171], v[152:155], v[32:47]
  ds_read_b128 v[172:175], v247 offset:3072
  ds_read_b128 v[188:191], v247 offset:19456
  ds_read_b128 v[204:207], v247 offset:35840
  s_waitcnt vmcnt(1)
  ds_write_b128 v249, v[232:235]
  s_waitcnt vmcnt(0)
  ds_write_b128 v249, v[236:239] offset:1024
  ds_read_b64_tr_b16 v[144:145], v250 offset:0
  ds_read_b64_tr_b16 v[146:147], v250 offset:512
  ds_read_b64_tr_b16 v[148:149], v250 offset:1024
  ds_read_b64_tr_b16 v[150:151], v250 offset:1536
  s_waitcnt lgkmcnt(15)
  v_pk_add_f32 v[160:161], v[160:161], v[176:177]
  v_pk_add_f32 v[162:163], v[162:163], v[178:179]
  v_pk_add_f32 v[160:161], v[160:161], v[192:193]
  v_pk_add_f32 v[162:163], v[162:163], v[194:195]
  s_waitcnt lgkmcnt(13)
  v_pk_add_f32 v[164:165], v[164:165], v[180:181]
  v_pk_add_f32 v[166:167], v[166:167], v[182:183]
  s_waitcnt lgkmcnt(12)
  v_pk_add_f32 v[164:165], v[164:165], v[196:197]
  v_pk_add_f32 v[166:167], v[166:167], v[198:199]
  s_waitcnt lgkmcnt(10)
  v_pk_add_f32 v[168:169], v[168:169], v[184:185]
  v_pk_add_f32 v[170:171], v[170:171], v[186:187]
  s_waitcnt lgkmcnt(9)
  v_pk_add_f32 v[168:169], v[168:169], v[200:201]
  v_pk_add_f32 v[170:171], v[170:171], v[202:203]
  s_waitcnt lgkmcnt(7)
  v_pk_add_f32 v[172:173], v[172:173], v[188:189]
  v_pk_add_f32 v[174:175], v[174:175], v[190:191]
  s_waitcnt lgkmcnt(6)
  v_pk_add_f32 v[172:173], v[172:173], v[204:205]
  v_pk_add_f32 v[174:175], v[174:175], v[206:207]
  v_pk_add_f32 v[32:33], v[32:33], v[160:161]
  v_pk_add_f32 v[34:35], v[34:35], v[162:163]
  v_pk_mul_f32 v[96:97], v[32:33], s[14:15] op_sel_hi:[1,0]
  v_pk_mul_f32 v[98:99], v[34:35], s[14:15] op_sel_hi:[1,0]
  v_exp_f32 v96, v96
  v_exp_f32 v97, v97
  v_exp_f32 v98, v98
  v_exp_f32 v99, v99
  v_pk_add_f32 v[36:37], v[36:37], v[164:165]
  v_pk_add_f32 v[38:39], v[38:39], v[166:167]
  v_pk_mul_f32 v[100:101], v[36:37], s[14:15] op_sel_hi:[1,0]
  v_pk_mul_f32 v[102:103], v[38:39], s[14:15] op_sel_hi:[1,0]
  v_exp_f32 v100, v100
  v_exp_f32 v101, v101
  v_exp_f32 v102, v102
  v_exp_f32 v103, v103
  v_pk_add_f32 v[40:41], v[40:41], v[168:169]
  v_pk_add_f32 v[42:43], v[42:43], v[170:171]
  v_pk_mul_f32 v[104:105], v[40:41], s[14:15] op_sel_hi:[1,0]
  v_pk_mul_f32 v[106:107], v[42:43], s[14:15] op_sel_hi:[1,0]
  v_exp_f32 v104, v104
  v_exp_f32 v105, v105
  v_exp_f32 v106, v106
  v_exp_f32 v107, v107
  v_pk_add_f32 v[44:45], v[44:45], v[172:173]
  v_pk_add_f32 v[46:47], v[46:47], v[174:175]
  v_pk_mul_f32 v[108:109], v[44:45], s[14:15] op_sel_hi:[1,0]
  v_pk_mul_f32 v[110:111], v[46:47], s[14:15] op_sel_hi:[1,0]
  v_exp_f32 v108, v108
  v_exp_f32 v109, v109
  v_exp_f32 v110, v110
  v_exp_f32 v111, v111
  v_pk_add_f32 v[96:97], v[96:97], 1.0 op_sel_hi:[1,0]
  v_pk_add_f32 v[98:99], v[98:99], 1.0 op_sel_hi:[1,0]
  v_pk_add_f32 v[100:101], v[100:101], 1.0 op_sel_hi:[1,0]
  v_pk_add_f32 v[102:103], v[102:103], 1.0 op_sel_hi:[1,0]
  v_pk_add_f32 v[104:105], v[104:105], 1.0 op_sel_hi:[1,0]
  v_pk_add_f32 v[106:107], v[106:107], 1.0 op_sel_hi:[1,0]
  v_pk_add_f32 v[108:109], v[108:109], 1.0 op_sel_hi:[1,0]
  v_pk_add_f32 v[110:111], v[110:111], 1.0 op_sel_hi:[1,0]
  v_rcp_f32 v96, v96
  v_rcp_f32 v97, v97
  s_waitcnt lgkmcnt(3)
  v_lshlrev_b32 v112, 16, v144
  v_and_b32 v113, 0xffff0000, v144
  v_rcp_f32 v98, v98
  v_rcp_f32 v99, v99
  v_lshlrev_b32 v114, 16, v145
  v_and_b32 v115, 0xffff0000, v145
  v_rcp_f32 v100, v100
  v_rcp_f32 v101, v101
  s_waitcnt lgkmcnt(2)
  v_lshlrev_b32 v116, 16, v146
  v_and_b32 v117, 0xffff0000, v146
  v_rcp_f32 v102, v102
  v_rcp_f32 v103, v103
  v_lshlrev_b32 v118, 16, v147
  v_and_b32 v119, 0xffff0000, v147
  v_rcp_f32 v104, v104
  v_rcp_f32 v105, v105
  s_waitcnt lgkmcnt(1)
  v_lshlrev_b32 v120, 16, v148
  v_and_b32 v121, 0xffff0000, v148
  v_rcp_f32 v106, v106
  v_rcp_f32 v107, v107
  v_lshlrev_b32 v122, 16, v149
  v_and_b32 v123, 0xffff0000, v149
  v_rcp_f32 v108, v108
  v_rcp_f32 v109, v109
  s_waitcnt lgkmcnt(0)
  v_lshlrev_b32 v124, 16, v150
  v_and_b32 v125, 0xffff0000, v150
  v_rcp_f32 v110, v110
  v_rcp_f32 v111, v111
  v_lshlrev_b32 v126, 16, v151
  v_and_b32 v127, 0xffff0000, v151
  v_pk_mul_f32 v[32:33], v[32:33], v[112:113]
  v_pk_mul_f32 v[34:35], v[34:35], v[114:115]
  v_pk_fma_f32 v[32:33], v[32:33], v[96:97], v[208:209]
  v_pk_fma_f32 v[34:35], v[34:35], v[98:99], v[210:211]
  v_cvt_pk_bf16_f32 v152, v32, v33
  v_cvt_pk_bf16_f32 v153, v34, v35
  v_pk_mul_f32 v[36:37], v[36:37], v[116:117]
  v_pk_mul_f32 v[38:39], v[38:39], v[118:119]
  v_pk_fma_f32 v[36:37], v[36:37], v[100:101], v[212:213]
  v_pk_fma_f32 v[38:39], v[38:39], v[102:103], v[214:215]
  v_cvt_pk_bf16_f32 v154, v36, v37
  v_cvt_pk_bf16_f32 v155, v38, v39
  s_nop 0
  v_permlane32_swap_b32 v152, v154
  v_permlane32_swap_b32 v153, v155
  ds_write_b128 v244, v[152:155] offset:0
  v_pk_mul_f32 v[40:41], v[40:41], v[120:121]
  v_pk_mul_f32 v[42:43], v[42:43], v[122:123]
  v_pk_fma_f32 v[40:41], v[40:41], v[104:105], v[216:217]
  v_pk_fma_f32 v[42:43], v[42:43], v[106:107], v[218:219]
  v_cvt_pk_bf16_f32 v156, v40, v41
  v_cvt_pk_bf16_f32 v157, v42, v43
  v_pk_mul_f32 v[44:45], v[44:45], v[124:125]
  v_pk_mul_f32 v[46:47], v[46:47], v[126:127]
  v_pk_fma_f32 v[44:45], v[44:45], v[108:109], v[220:221]
  v_pk_fma_f32 v[46:47], v[46:47], v[110:111], v[222:223]
  v_cvt_pk_bf16_f32 v158, v44, v45
  v_cvt_pk_bf16_f32 v159, v46, v47
  s_nop 0
  v_permlane32_swap_b32 v156, v158
  v_permlane32_swap_b32 v157, v159
  ds_write_b128 v244, v[156:159] offset:32
  s_waitcnt lgkmcnt(0)
  s_barrier
  ds_read_b128 v[152:155], v246
  ds_read_b128 v[156:159], v246 offset:1152
  s_waitcnt lgkmcnt(1)
  buffer_store_dwordx4 v[152:155], v251, s[68:71], s36 offen sc1
  s_waitcnt lgkmcnt(0)
  buffer_store_dwordx4 v[156:159], v251, s[68:71], s37 offen sc1
  s_cmp_eq_u32 s92, 0
  s_cbranch_scc0 L_fin
  s_mov_b32 s12, 13107200
  s_mov_b64 exec, 1
  buffer_store_dword v5, v6, s[56:59], s12 offen sc1
  s_mov_b64 exec, -1
L_fin:
L_end:
  s_endpgm
L_spin0:
  s_mov_b32 s33, 0
L_spinl0:
  buffer_load_dword v23, v18, s[56:59], 0 offen sc1
  s_add_u32 s33, s33, 1
  s_waitcnt vmcnt(0)
  v_cmp_ne_u32 vcc, s11, v23
  s_cbranch_vccz L_back0
  s_cmp_lt_u32 s33, 100000
  s_cbranch_scc1 L_spinl0
  s_branch L_back0
L_spin1:
  s_mov_b32 s33, 0
L_spinl1:
  buffer_load_dword v23, v19, s[56:59], 0 offen sc1
  s_add_u32 s33, s33, 1
  s_waitcnt vmcnt(0)
  v_cmp_ne_u32 vcc, s11, v23
  s_cbranch_vccz L_back1
  s_cmp_lt_u32 s33, 100000
  s_cbranch_scc1 L_spinl1
  s_branch L_back1
L_spin2:
  s_mov_b32 s33, 0
L_spinl2:
  buffer_load_dword v24, v20, s[56:59], 0 offen sc1
  s_add_u32 s33, s33, 1
  s_waitcnt vmcnt(0)
  v_cmp_ne_u32 vcc, s11, v24
  s_cbranch_vccz L_back2
  s_cmp_lt_u32 s33, 100000
  s_cbranch_scc1 L_spinl2
  s_branch L_back2
L_spin3:
  s_mov_b32 s33, 0
L_spinl3:
  buffer_load_dword v23, v21, s[56:59], 0 offen sc1
  s_add_u32 s33, s33, 1
  s_waitcnt vmcnt(0)
  v_cmp_ne_u32 vcc, s11, v23
  s_cbranch_vccz L_back3
  s_cmp_lt_u32 s33, 100000
  s_cbranch_scc1 L_spinl3
  s_branch L_back3
L_spin4:
  s_mov_b32 s33, 0
L_spinl4:
  buffer_load_dword v23, v22, s[56:59], 0 offen sc1
  s_add_u32 s33, s33, 1
  s_waitcnt vmcnt(0)
  v_cmp_ne_u32 vcc, s11, v23
  s_cbranch_vccz L_back4
  s_cmp_lt_u32 s33, 100000
  s_cbranch_scc1 L_spinl4
  s_branch L_back4
  .fill 4096, 4, 0xbf800000
.section .rodata,"a"
.p2align 6
.amdhsa_kernel recurrent_scan__ssm_conv_s4__dense_activation_squared_relu__prompt_kernel
  .amdhsa_next_free_vgpr 512
  .amdhsa_next_free_sgpr 102
  .amdhsa_accum_offset 256
  .amdhsa_group_segment_fixed_size 0
  .amdhsa_kernarg_size 136
  .amdhsa_user_sgpr_count 2
  .amdhsa_user_sgpr_kernarg_segment_ptr 1
  .amdhsa_system_sgpr_workgroup_id_x 1
.end_amdhsa_kernel
```
